```python
import torch

def _softmax(x, axis=-1):
    return torch.softmax(x, dim=axis)
def _gelu(x):
    return torch.nn.functional.gelu(x, approximate="tanh")
def _silu(x):
    return torch.nn.functional.silu(x)
def _sigmoid(x):
    return torch.sigmoid(x)
def _layernorm(x, axis=-1, eps=1e-5):
    m = x.mean(dim=axis, keepdim=True)
    v = x.var(dim=axis, keepdim=True, unbiased=False)
    return (x - m) / torch.sqrt(v + eps)
def _scatter_add(tgt, idx, src, axis=0):
    return tgt.clone().index_add_(axis, idx, src)
def _segment_sum(src, seg, n):
    out = torch.zeros((n,) + src.shape[1:], dtype=src.dtype)
    return out.index_add_(0, seg, src)
def _pad(x, pw):
    flat = tuple(v for pair in reversed(pw) for v in pair)
    return torch.nn.functional.pad(x, flat)

kernel_name = 'sequential_preLN__sliding_block_cached__dense_activation_relu__decode'

def setup_inputs():

    _w = (lambda a: (lambda t: t.to(torch.bfloat16) if t.is_floating_point() else t)(torch.as_tensor(a)))
    def _A_setup():
        B, Sq, D = 1, 1, 576
        Hq, Hkv, Sk, Dh = 32, 16, 65536, 128
        assert Hq % Hkv == 0, (Hq, Hkv)
        return {
            "x": _w((lambda *s: torch.randn(*s, dtype=torch.bfloat16) * 0.05)(B, Sq, D)),
            "k_cache": _w((lambda *s: torch.randn(*s, dtype=torch.bfloat16) * 3.2)(B, Hkv, Sk, Dh)),
            "v_cache": _w((lambda *s: torch.randn(*s, dtype=torch.bfloat16) * 0.4)(B, Hkv, Sk, Dh)),
            "wq": _w((lambda *s: torch.randn(*s, dtype=torch.bfloat16) * 3.2)(D, Hq * Dh) * (D ** -0.5)),
            "wo": _w((lambda *s: torch.randn(*s, dtype=torch.bfloat16) * 0.4)(Hq * Dh, D) * ((Hq * Dh) ** -0.5)),
        }
    _A_in = _A_setup()

    def _B_setup():
        B, S, D, Dff = 1, 1, 576, 4608
        return {
            "x": _w((lambda *s: torch.randn(*s, dtype=torch.bfloat16) * 0.05)(B, S, D)),
            "w1": _w((lambda *s: torch.randn(*s, dtype=torch.bfloat16) * 0.05)(D, Dff)),
            "w2": _w((lambda *s: torch.randn(*s, dtype=torch.bfloat16) * 0.05)(Dff, D)),
        }
    _B_in = _B_setup()

    return {
        "A_x": _A_in["x"],
        "A_k_cache": _A_in["k_cache"],
        "A_v_cache": _A_in["v_cache"],
        "A_wq": _A_in["wq"],
        "A_wo": _A_in["wo"],
        "B_x": _B_in["x"],
        "B_w1": _B_in["w1"],
        "B_w2": _B_in["w2"],
    }

def reference(A_x, A_k_cache, A_v_cache, A_wq, A_wo, B_x, B_w1, B_w2):
    def _A_ref(x, k_cache, v_cache, wq, wo):
        B, Sq, D = x.shape
        Hq, Dh = 32, 128
        Hkv, Sk = k_cache.shape[1], k_cache.shape[2]
        W = min(4096, max(256, Sk // 4))
        rep = Hq // Hkv
        q = (lambda x, *d: x.permute(*d))((x @ wq).reshape(B, Sq, Hq, Dh), 0, 2, 1, 3)
        k = (lambda x, n, axis: torch.repeat_interleave(x, n, dim=axis))(k_cache[:, :, Sk - W:, :], rep, axis=1)
        v = (lambda x, n, axis: torch.repeat_interleave(x, n, dim=axis))(v_cache[:, :, Sk - W:, :], rep, axis=1)
        scores = torch.einsum("bhqd,bhkd->bhqk", q, k) * (Dh ** -0.5)
        p = _softmax(scores, axis=-1)
        o = torch.einsum("bhqk,bhkd->bhqd", p, v)
        return (lambda x, *d: x.permute(*d))(o, 0, 2, 1, 3).reshape(B, Sq, Hq * Dh) @ wo

    def _B_ref(x, w1, w2):
        h = torch.einsum("bsd,df->bsf", x, w1)
        zero = torch.zeros_like(h)
        h = torch.maximum(h, zero)
        return torch.einsum("bsf,fd->bsd", h, w2)

    x = A_x
    h = x + _A_ref(_layernorm(x, axis=-1), A_k_cache, A_v_cache, A_wq, A_wo)
    h2 = h + _B_ref(_layernorm(h, axis=-1), B_w1, B_w2)
    return h2
```

```asm
; @launch grid=(256,1,1) block=(576,1,1) lds=18560
.amdgcn_target "amdgcn-amd-amdhsa--gfx950"
.text
.globl sequential_preLN__sliding_block_cached__dense_activation_relu__decode_kernel
.p2align 8
.type sequential_preLN__sliding_block_cached__dense_activation_relu__decode_kernel,@function
sequential_preLN__sliding_block_cached__dense_activation_relu__decode_kernel:
    s_cmp_ge_u32 s2, 256
    s_cbranch_scc1 Lend
    s_load_dwordx16 s[36:51], s[0:1], 0
    s_load_dwordx2 s[32:33], s[0:1], 64
    s_load_dwordx2 s[28:29], s[0:1], 80
    v_lshrrev_b32 v5, 6, v0
    v_and_b32 v1, 63, v0
    v_readfirstlane_b32 s3, v5
    v_and_b32 v2, 15, v0
    v_lshrrev_b32 v3, 4, v1
    v_mov_b32 v4, 0xffffff00
    s_and_b32 s56, s2, 7
    s_lshr_b32 s57, s2, 3
    s_and_b32 s58, s57, 1
    s_lshl1_add_u32 s58, s56, s58
    s_lshr_b32 s59, s57, 1
    s_mov_b32 s65, 0x05040100
    s_mov_b32 s66, 0x07060302
    s_mov_b32 s67, 0x0c0c0400
    s_mov_b32 s68, 0x04000c0c
    s_mov_b32 s6, 1152
    s_mov_b32 s7, 0x20000
    s_mov_b32 s10, 65536
    s_mov_b32 s11, 0x20000
    s_mov_b32 s14, 65536
    s_mov_b32 s15, 0x20000
    s_mov_b32 s18, 4718592
    s_mov_b32 s19, 0x20000
    s_mov_b32 s23, 0x20000
    s_mov_b32 s26, 5308416
    s_mov_b32 s27, 0x20000
    s_mov_b32 s30, 0x40000000
    s_mov_b32 s31, 0x20000
    s_mov_b32 s34, 1152
    s_mov_b32 s35, 0x20000
    s_lshl_b32 s52, s58, 24
    s_add_u32 s53, s59, 240
    s_lshl_b32 s53, s53, 16
    s_add_u32 s52, s52, s53
    s_lshr_b32 s53, s59, 2
    s_mul_i32 s53, s53, 9
    s_add_u32 s53, s53, s3
    s_lshl_b32 s54, s53, 17
    s_lshl_b32 s53, s53, 5
    s_lshl_b32 s55, s58, 2
    s_and_b32 s69, s59, 3
    s_add_u32 s55, s55, s69
    s_lshl_b32 s55, s55, 7
    s_add_u32 s54, s54, s55
    v_lshlrev_b32 v7, 4, v1
    v_lshlrev_b32 v24, 3, v3
    v_and_b32 v25, 3, v0
    v_lshl_add_u32 v25, v3, 2, v25
    v_lshl_add_u32 v25, v5, 4, v25
    v_lshlrev_b32 v31, 3, v25
    v_lshlrev_b32 v26, 3, v2
    v_lshl_add_u32 v27, v3, 15, v26
    v_mov_b32 v28, 0
    s_mov_b32 s69, 0
    s_cmp_lt_u32 s57, 18
    s_cselect_b32 s69, 1, s69
    s_sub_u32 s70, s57, 18
    s_cmp_lt_u32 s70, 9
    s_cselect_b32 s69, 2, s69
    s_mul_i32 s71, s56, 9
    s_add_u32 s70, s70, s71
    s_waitcnt lgkmcnt(0)
    s_mov_b64 s[4:5], s[36:37]
    s_mov_b32 s13, s41
    s_mov_b64 s[16:17], s[42:43]
    buffer_load_dword v6, v28, s[28:31], 0 offen sc1
    buffer_load_dwordx4 v[8:11], v7, s[4:7], 0 offen
    buffer_load_dwordx4 v[12:15], v7, s[4:7], 0 offen offset:1024
    buffer_load_dwordx2 v[16:17], v24, s[4:7], s53 offen
    buffer_load_dwordx2 v[18:19], v31, s[4:7], 0 offen
    s_add_u32 s41, s54, 0
    buffer_load_dwordx2 v[128:129], v27, s[16:19], s41 offen nt
    s_add_u32 s41, s54, 8192
    buffer_load_dwordx2 v[130:131], v27, s[16:19], s41 offen nt
    s_add_u32 s41, s54, 16384
    buffer_load_dwordx2 v[132:133], v27, s[16:19], s41 offen nt
    s_add_u32 s41, s54, 24576
    buffer_load_dwordx2 v[134:135], v27, s[16:19], s41 offen nt
    s_add_u32 s8, s38, s52
    s_addc_u32 s9, s39, 0
    s_add_u32 s12, s40, s52
    s_addc_u32 s13, s13, 0
    s_mov_b64 s[24:25], s[50:51]
    s_mov_b64 s[20:21], s[48:49]
    s_mov_b32 s22, 5308416
    s_cmp_eq_u32 s69, 1
    s_cbranch_scc0 Lnx
    s_mov_b64 s[20:21], s[44:45]
    s_mov_b32 s22, 4718592
Lnx:
    v_lshrrev_b32 v20, 3, v2
    v_lshl_add_u32 v20, v20, 2, v3
    v_and_b32 v21, 7, v2
    v_lshlrev_b32 v21, 4, v21
    v_mul_u32_u24 v29, 73728, v20
    v_add_u32 v29, v29, v21
    v_mul_u32_u24 v27, 4608, v20
    v_add_u32 v27, v27, v21
    v_lshrrev_b32 v20, 1, v3
    v_lshlrev_b32 v26, 1, v21
    v_lshl_add_u32 v26, v20, 4, v26
    v_lshrrev_b32 v20, 3, v2
    v_lshl_add_u32 v26, v20, 8, v26
    v_lshl_add_u32 v20, v20, 4, v3
    v_mul_u32_u24 v30, 1152, v20
    v_add_u32 v30, v30, v21
    s_mov_b32 s36, -1
    s_mov_b32 s37, 0
    s_lshl4_add_u32 s55, s58, s59
    s_mul_i32 s51, s55, 1152
    s_add_u32 s51, s51, 131072
    s_lshl_b32 s55, s55, 8
    s_add_u32 s55, s55, 65536
    s_barrier
    s_cmp_eq_u32 s3, 0
    s_cbranch_scc1 Lhelp
    s_sub_u32 s50, s3, 1
    s_lshl_b32 s41, s50, 13
    v_lshrrev_b32 v24, 2, v2
    v_lshlrev_b32 v24, 11, v24
    v_lshl_add_u32 v24, v3, 6, v24
    v_and_b32 v25, 3, v2
    v_lshl_add_u32 v24, v25, 4, v24
    v_mov_b32 v5, v24
    buffer_load_dwordx4 v[32:35], v5, s[8:11], s41 offen offset:0 nt
    buffer_load_dwordx4 v[36:39], v5, s[8:11], s41 offen offset:256 nt
    s_waitcnt vmcnt(6)
    v_mov_b32 v20, 0x3f803f80
    v_dot2_f32_bf16 v21, v8, v20, 0
    v_dot2_f32_bf16 v22, v8, v8, 0
    v_dot2_f32_bf16 v23, v12, v20, 0
    v_dot2_f32_bf16 v24, v12, v12, 0
    v_dot2_f32_bf16 v21, v9, v20, v21
    v_dot2_f32_bf16 v22, v9, v9, v22
    v_dot2_f32_bf16 v23, v13, v20, v23
    v_dot2_f32_bf16 v24, v13, v13, v24
    v_dot2_f32_bf16 v21, v10, v20, v21
    v_dot2_f32_bf16 v22, v10, v10, v22
    v_dot2_f32_bf16 v23, v14, v20, v23
    v_dot2_f32_bf16 v24, v14, v14, v24
    v_dot2_f32_bf16 v21, v11, v20, v21
    v_dot2_f32_bf16 v22, v11, v11, v22
    v_dot2_f32_bf16 v23, v15, v20, v23
    v_dot2_f32_bf16 v24, v15, v15, v24
    v_readfirstlane_b32 s64, v6
    s_nop 0
    v_add_f32 v23, v21, v23
    v_add_f32 v21, v22, v24
    v_mov_b32 v22, v23
    v_mov_b32 v23, v21
    s_nop 0
    v_add_f32_dpp v22, v22, v22 quad_perm:[1,0,3,2] row_mask:0xf bank_mask:0xf
    v_add_f32_dpp v23, v23, v23 quad_perm:[1,0,3,2] row_mask:0xf bank_mask:0xf
    s_nop 0
    v_add_f32_dpp v22, v22, v22 quad_perm:[2,3,0,1] row_mask:0xf bank_mask:0xf
    v_add_f32_dpp v23, v23, v23 quad_perm:[2,3,0,1] row_mask:0xf bank_mask:0xf
    s_nop 0
    v_add_f32_dpp v22, v22, v22 row_ror:4 row_mask:0xf bank_mask:0xf
    v_add_f32_dpp v23, v23, v23 row_ror:4 row_mask:0xf bank_mask:0xf
    s_nop 0
    v_add_f32_dpp v22, v22, v22 row_ror:8 row_mask:0xf bank_mask:0xf
    v_add_f32_dpp v23, v23, v23 row_ror:8 row_mask:0xf bank_mask:0xf
    v_mov_b32 v20, v22
    v_mov_b32 v21, v23
    s_nop 0
    v_permlane16_swap_b32 v20, v22
    v_permlane16_swap_b32 v21, v23
    v_add_f32 v22, v20, v22
    v_add_f32 v23, v21, v23
    v_mov_b32 v20, v22
    v_mov_b32 v21, v23
    s_nop 0
    v_permlane32_swap_b32 v20, v22
    v_permlane32_swap_b32 v21, v23
    v_add_f32 v22, v20, v22
    v_add_f32 v23, v21, v23
    s_mul_i32 s64, s64, 0x9E3779B1
    s_add_u32 s64, s64, 0x7F4A7C15
    s_and_b32 s60, s64, 0xff
    s_bfe_u32 s61, s64, 0x80008
    s_bfe_u32 s62, s64, 0x80010
    s_lshr_b32 s63, s64, 24
    v_mul_f32 v22, 0x3ae38e39, v22
    v_mul_f32 v23, 0x3ae38e39, v23
    v_fma_f32 v23, -v22, v22, v23
    v_max_f32 v23, 0, v23
    v_cvt_pk_bf16_f32 v21, v22, v23
    v_lshlrev_b32 v22, 16, v21
    v_and_b32 v23, 0xffff0000, v21
    v_add_f32 v23, 0x3727c5ac, v23
    v_cvt_pk_bf16_f32 v23, v23, v23
    v_and_b32 v23, 0xffff0000, v23
    v_sqrt_f32 v23, v23
    s_nop 0
    v_cvt_pk_bf16_f32 v23, v23, v23
    v_and_b32 v23, 0xffff0000, v23
    v_rcp_f32 v23, v23
    v_and_b32 v9, 0xffff0000, v16
    v_lshlrev_b32 v8, 16, v16
    v_and_b32 v11, 0xffff0000, v17
    v_lshlrev_b32 v10, 16, v17
    v_pk_add_f32 v[8:9], v[8:9], v[22:23] op_sel_hi:[1,0] neg_lo:[0,1] neg_hi:[0,1]
    v_pk_add_f32 v[10:11], v[10:11], v[22:23] op_sel_hi:[1,0] neg_lo:[0,1] neg_hi:[0,1]
    v_cvt_pk_bf16_f32 v16, v8, v9
    v_cvt_pk_bf16_f32 v17, v10, v11
    v_and_b32 v9, 0xffff0000, v16
    v_lshlrev_b32 v8, 16, v16
    v_and_b32 v11, 0xffff0000, v17
    v_lshlrev_b32 v10, 16, v17
    v_pk_mul_f32 v[8:9], v[8:9], v[22:23] op_sel:[0,1] op_sel_hi:[1,1]
    v_pk_mul_f32 v[10:11], v[10:11], v[22:23] op_sel:[0,1] op_sel_hi:[1,1]
    v_cvt_pk_bf16_f32 v16, v8, v9
    v_cvt_pk_bf16_f32 v17, v10, v11
    s_lshl_b32 s41, s3, 8
    v_lshl_add_u32 v24, v2, 4, s41
    s_waitcnt vmcnt(2)
    v_perm_b32 v136, v130, v128, s65
    v_perm_b32 v137, v134, v132, s65
    v_perm_b32 v138, v130, v128, s66
    v_perm_b32 v139, v134, v132, s66
    v_perm_b32 v140, v131, v129, s65
    v_perm_b32 v141, v135, v133, s65
    v_perm_b32 v142, v131, v129, s66
    v_perm_b32 v143, v135, v133, s66
    v_mfma_f32_16x16x16_bf16 v[144:147], v[16:17], v[136:137], 0
    v_mfma_f32_16x16x16_bf16 v[148:151], v[16:17], v[138:139], 0
    v_mfma_f32_16x16x16_bf16 v[152:155], v[16:17], v[140:141], 0
    v_mfma_f32_16x16x16_bf16 v[156:159], v[16:17], v[142:143], 0
    s_nop 4
    v_mov_b32 v20, v144
    v_mov_b32 v21, v148
    v_mov_b32 v22, v152
    v_mov_b32 v23, v156
    s_mov_b32 exec_lo, 0xffff
    s_mov_b32 exec_hi, 0
    ds_write_b128 v24, v[20:23]
    s_mov_b64 exec, -1
    s_waitcnt lgkmcnt(0)
    s_barrier
    v_lshlrev_b32 v24, 11, v3
    v_lshl_add_u32 v24, v2, 4, v24
    s_lshl_b32 s45, s50, 13
    buffer_load_dwordx4 v[40:43], v5, s[8:11], s45 offen offset:512 nt
    s_waitcnt vmcnt(2)
    buffer_load_dwordx4 v[44:47], v5, s[8:11], s45 offen offset:768 nt
    s_waitcnt vmcnt(2)
    buffer_load_dwordx4 v[48:51], v5, s[8:11], s45 offen offset:1024 nt
    s_waitcnt vmcnt(2)
    buffer_load_dwordx4 v[52:55], v5, s[8:11], s45 offen offset:1280 nt
    s_waitcnt vmcnt(2)
    buffer_load_dwordx4 v[56:59], v5, s[8:11], s45 offen offset:1536 nt
    s_waitcnt vmcnt(2)
    buffer_load_dwordx4 v[60:63], v5, s[8:11], s45 offen offset:1792 nt
    s_waitcnt vmcnt(2)
    buffer_load_dwordx4 v[64:67], v24, s[12:15], s45 offen offset:0 nt
    s_waitcnt vmcnt(2)
    buffer_load_dwordx4 v[68:71], v24, s[12:15], s45 offen offset:256 nt
    s_waitcnt vmcnt(2)
    buffer_load_dwordx4 v[72:75], v24, s[12:15], s45 offen offset:512 nt
    s_waitcnt vmcnt(2)
    buffer_load_dwordx4 v[76:79], v24, s[12:15], s45 offen offset:768 nt
    s_waitcnt vmcnt(2)
    buffer_load_dwordx4 v[80:83], v24, s[12:15], s45 offen offset:1024 nt
    buffer_load_dwordx4 v[84:87], v24, s[12:15], s45 offen offset:1280 nt
    buffer_load_dwordx4 v[88:91], v24, s[12:15], s45 offen offset:1536 nt
    buffer_load_dwordx4 v[92:95], v24, s[12:15], s45 offen offset:1792 nt
    v_bfe_u32 v8, v2, 2, 1
    v_lshlrev_b32 v31, 8, v8
    v_lshl_add_u32 v31, v3, 6, v31
    v_lshl_add_u32 v31, v25, 4, v31
    s_lshl_b32 s41, s50, 7
    v_lshlrev_b32 v9, 6, v8
    v_lshl_add_u32 v9, v3, 4, v9
    v_add_u32 v9, s41, v9
    v_and_b32 v10, 1, v3
    v_lshlrev_b32 v8, 6, v10
    v_lshrrev_b32 v12, 2, v2
    v_lshl_add_u32 v11, v12, 4, v8
    v_lshrrev_b32 v12, 1, v3
    v_lshl_add_u32 v11, v12, 3, v11
    v_add_u32 v11, s41, v11
    v_lshlrev_b32 v10, 9, v10
    v_lshl_add_u32 v10, v2, 5, v10
    v_lshl_add_u32 v10, v12, 4, v10
    s_lshl_b32 s41, s50, 10
    v_add_u32 v10, s41, v10
    s_lshl_b32 s41, s50, 3
    v_add_u32 v6, s41, v8
    s_barrier
    ds_read_b128 v[20:23], v31 offset:2560
    s_waitcnt vmcnt(8) lgkmcnt(0)
    v_mfma_f32_16x16x32_bf16 v[128:131], v[20:23], v[32:35], 0
    v_mfma_f32_16x16x32_bf16 v[132:135], v[20:23], v[36:39], 0
    v_mfma_f32_16x16x32_bf16 v[136:139], v[20:23], v[40:43], 0
    v_mfma_f32_16x16x32_bf16 v[140:143], v[20:23], v[44:47], 0
    v_mfma_f32_16x16x32_bf16 v[144:147], v[20:23], v[48:51], 0
    v_mfma_f32_16x16x32_bf16 v[148:151], v[20:23], v[52:55], 0
    v_mfma_f32_16x16x32_bf16 v[152:155], v[20:23], v[56:59], 0
    v_mfma_f32_16x16x32_bf16 v[156:159], v[20:23], v[60:63], 0
    s_nop 0
    v_add_f32_dpp v128, v129, v128 quad_perm:[1,1,1,1] row_mask:0xf bank_mask:0xf
    v_add_f32_dpp v132, v133, v132 quad_perm:[1,1,1,1] row_mask:0xf bank_mask:0xf
    v_add_f32_dpp v136, v137, v136 quad_perm:[1,1,1,1] row_mask:0xf bank_mask:0xf
    v_add_f32_dpp v140, v141, v140 quad_perm:[1,1,1,1] row_mask:0xf bank_mask:0xf
    v_add_f32_dpp v144, v145, v144 quad_perm:[1,1,1,1] row_mask:0xf bank_mask:0xf
    v_add_f32_dpp v148, v149, v148 quad_perm:[1,1,1,1] row_mask:0xf bank_mask:0xf
    v_add_f32_dpp v152, v153, v152 quad_perm:[1,1,1,1] row_mask:0xf bank_mask:0xf
    v_add_f32_dpp v156, v157, v156 quad_perm:[1,1,1,1] row_mask:0xf bank_mask:0xf
    v_add_f32_dpp v128, v130, v128 quad_perm:[2,2,2,2] row_mask:0xf bank_mask:0xf
    v_add_f32_dpp v132, v134, v132 quad_perm:[2,2,2,2] row_mask:0xf bank_mask:0xf
    v_add_f32_dpp v136, v138, v136 quad_perm:[2,2,2,2] row_mask:0xf bank_mask:0xf
    v_add_f32_dpp v140, v142, v140 quad_perm:[2,2,2,2] row_mask:0xf bank_mask:0xf
    v_add_f32_dpp v144, v146, v144 quad_perm:[2,2,2,2] row_mask:0xf bank_mask:0xf
    v_add_f32_dpp v148, v150, v148 quad_perm:[2,2,2,2] row_mask:0xf bank_mask:0xf
    v_add_f32_dpp v152, v154, v152 quad_perm:[2,2,2,2] row_mask:0xf bank_mask:0xf
    v_add_f32_dpp v156, v158, v156 quad_perm:[2,2,2,2] row_mask:0xf bank_mask:0xf
    v_add_f32_dpp v128, v131, v128 quad_perm:[3,3,3,3] row_mask:0xf bank_mask:0xf
    v_add_f32_dpp v132, v135, v132 quad_perm:[3,3,3,3] row_mask:0xf bank_mask:0xf
    v_add_f32_dpp v136, v139, v136 quad_perm:[3,3,3,3] row_mask:0xf bank_mask:0xf
    v_add_f32_dpp v140, v143, v140 quad_perm:[3,3,3,3] row_mask:0xf bank_mask:0xf
    v_add_f32_dpp v144, v147, v144 quad_perm:[3,3,3,3] row_mask:0xf bank_mask:0xf
    v_add_f32_dpp v148, v151, v148 quad_perm:[3,3,3,3] row_mask:0xf bank_mask:0xf
    v_add_f32_dpp v152, v155, v152 quad_perm:[3,3,3,3] row_mask:0xf bank_mask:0xf
    v_add_f32_dpp v156, v159, v156 quad_perm:[3,3,3,3] row_mask:0xf bank_mask:0xf
    v_cndmask_b32 v12, v144, v128, s[36:37]
    v_cndmask_b32 v13, v148, v132, s[36:37]
    v_cndmask_b32 v14, v152, v136, s[36:37]
    v_cndmask_b32 v15, v156, v140, s[36:37]
    v_cvt_pk_bf16_f32 v16, v12, v13
    v_cvt_pk_bf16_f32 v17, v14, v15
    v_and_b32 v13, 0xffff0000, v16
    v_lshlrev_b32 v12, 16, v16
    v_and_b32 v15, 0xffff0000, v17
    v_lshlrev_b32 v14, 16, v17
    v_mul_f32 v12, 0x3db504f3, v12
    v_mul_f32 v13, 0x3db504f3, v13
    v_mul_f32 v14, 0x3db504f3, v14
    v_mul_f32 v15, 0x3db504f3, v15
    v_cvt_pk_bf16_f32 v16, v12, v13
    v_cvt_pk_bf16_f32 v17, v14, v15
    v_and_b32 v13, 0xffff0000, v16
    v_lshlrev_b32 v12, 16, v16
    v_and_b32 v15, 0xffff0000, v17
    v_lshlrev_b32 v14, 16, v17
    v_max3_f32 v16, v12, v13, v14
    v_max_f32 v16, v16, v15
    s_nop 1
    v_max_f32_dpp v16, v16, v16 row_ror:4 row_mask:0xf bank_mask:0xf
    s_nop 1
    v_max_f32_dpp v16, v16, v16 row_ror:8 row_mask:0xf bank_mask:0xf
    v_mov_b32 v20, v16
    s_nop 1
    v_permlane32_swap_b32 v20, v16
    v_max_f32 v16, v20, v16
    v_sub_f32 v12, v12, v16
    v_sub_f32 v13, v13, v16
    v_sub_f32 v14, v14, v16
    v_sub_f32 v15, v15, v16
    v_mul_f32 v12, 0x3fb8aa3b, v12
    v_mul_f32 v13, 0x3fb8aa3b, v13
    v_mul_f32 v14, 0x3fb8aa3b, v14
    v_mul_f32 v15, 0x3fb8aa3b, v15
    v_exp_f32 v12, v12
    v_exp_f32 v13, v13
    v_exp_f32 v14, v14
    v_exp_f32 v15, v15
    v_cvt_pk_bf16_f32 v20, v12, v13
    v_cvt_pk_bf16_f32 v21, v14, v15
    v_add_f32 v17, v12, v13
    v_add_f32 v14, v14, v15
    v_add_f32 v17, v17, v14
    s_mov_b32 exec_lo, 0x11111111
    s_mov_b32 exec_hi, 0x11111111
    ds_write_b64 v11, v[20:21] offset:3072
    s_mov_b64 exec, -1
    ds_read_b128 v[20:23], v9 offset:3072
    v_add_f32_dpp v17, v17, v17 row_ror:4 row_mask:0xf bank_mask:0xf
    s_nop 1
    v_add_f32_dpp v17, v17, v17 row_ror:8 row_mask:0xf bank_mask:0xf
    v_mov_b32 v12, v17
    s_nop 1
    v_permlane32_swap_b32 v12, v17
    v_add_f32 v17, v12, v17
    s_mov_b32 exec_lo, 0x00010001
    s_mov_b32 exec_hi, 0
    ds_write_b64 v6, v[16:17] offset:4096
    s_mov_b64 exec, -1
    ds_read_b32 v16, v6 offset:4096
    s_waitcnt lgkmcnt(0)
    s_barrier
    ds_read_b128 v[128:131], v8 offset:4096
    ds_read_b128 v[132:135], v8 offset:4112
    ds_read_b128 v[136:139], v8 offset:4128
    ds_read_b128 v[140:143], v8 offset:4144
    s_cmp_eq_u32 s69, 1
    s_cbranch_scc1 Lax
    s_cmp_eq_u32 s69, 2
    s_cbranch_scc1 Lay
    s_waitcnt lgkmcnt(0)
    v_max3_f32 v12, v128, v130, v132
    v_max3_f32 v13, v134, v136, v138
    v_max3_f32 v12, v12, v140, v142
    v_max_f32 v12, v12, v13
    v_sub_f32 v16, v16, v12
    v_mul_f32 v16, 0x3fb8aa3b, v16
    v_exp_f32 v16, v16
    s_waitcnt vmcnt(4)
    v_perm_b32 v32, v68, v64, s65
    v_perm_b32 v36, v68, v64, s66
    v_perm_b32 v40, v69, v65, s65
    v_perm_b32 v44, v69, v65, s66
    v_perm_b32 v48, v70, v66, s65
    v_perm_b32 v52, v70, v66, s66
    v_perm_b32 v56, v71, v67, s65
    v_perm_b32 v60, v71, v67, s66
    v_perm_b32 v33, v76, v72, s65
    v_perm_b32 v37, v76, v72, s66
    v_perm_b32 v41, v77, v73, s65
    v_perm_b32 v45, v77, v73, s66
    v_perm_b32 v49, v78, v74, s65
    v_perm_b32 v53, v78, v74, s66
    v_perm_b32 v57, v79, v75, s65
    v_perm_b32 v61, v79, v75, s66
    s_waitcnt vmcnt(2)
    v_perm_b32 v34, v84, v80, s65
    v_perm_b32 v38, v84, v80, s66
    v_perm_b32 v42, v85, v81, s65
    v_perm_b32 v46, v85, v81, s66
    v_perm_b32 v50, v86, v82, s65
    v_perm_b32 v54, v86, v82, s66
    v_perm_b32 v58, v87, v83, s65
    v_perm_b32 v62, v87, v83, s66
    s_waitcnt vmcnt(0)
    v_perm_b32 v35, v92, v88, s65
    v_perm_b32 v39, v92, v88, s66
    v_perm_b32 v43, v93, v89, s65
    v_perm_b32 v47, v93, v89, s66
    v_perm_b32 v51, v94, v90, s65
    v_perm_b32 v55, v94, v90, s66
    v_perm_b32 v59, v95, v91, s65
    v_perm_b32 v63, v95, v91, s66
    v_mfma_f32_16x16x32_bf16 v[64:67], v[20:23], v[32:35], 0
    v_mfma_f32_16x16x32_bf16 v[68:71], v[20:23], v[36:39], 0
    v_mfma_f32_16x16x32_bf16 v[72:75], v[20:23], v[40:43], 0
    v_mfma_f32_16x16x32_bf16 v[76:79], v[20:23], v[44:47], 0
    v_mfma_f32_16x16x32_bf16 v[80:83], v[20:23], v[48:51], 0
    v_mfma_f32_16x16x32_bf16 v[84:87], v[20:23], v[52:55], 0
    v_mfma_f32_16x16x32_bf16 v[88:91], v[20:23], v[56:59], 0
    v_mfma_f32_16x16x32_bf16 v[92:95], v[20:23], v[60:63], 0
    s_nop 4
    v_cndmask_b32 v12, v80, v64, s[36:37]
    v_cndmask_b32 v13, v84, v68, s[36:37]
    v_cndmask_b32 v14, v88, v72, s[36:37]
    v_cndmask_b32 v15, v92, v76, s[36:37]
    v_mul_f32 v12, v12, v16
    v_mul_f32 v13, v13, v16
    v_mul_f32 v14, v14, v16
    v_mul_f32 v15, v15, v16
    ds_write_b128 v10, v[12:15] offset:5120
    s_waitcnt lgkmcnt(0)
    s_barrier
    s_branch Lfin
Lay:
    s_mul_i32 s42, s3, 589824
    s_lshl_b32 s43, s70, 7
    s_add_u32 s42, s42, s43
    s_mul_i32 s43, s70, 73728
    s_lshl_b32 s44, s3, 7
    s_add_u32 s43, s43, s44
    s_add_u32 s41, s42, 0
    buffer_load_dwordx4 v[96:99], v29, s[20:23], s41 offen nt
    s_add_u32 s41, s42, 9216
    buffer_load_dwordx4 v[100:103], v29, s[20:23], s41 offen nt
    s_waitcnt lgkmcnt(0)
    v_max3_f32 v12, v128, v130, v132
    v_max3_f32 v13, v134, v136, v138
    v_max3_f32 v12, v12, v140, v142
    v_max_f32 v12, v12, v13
    v_sub_f32 v16, v16, v12
    v_mul_f32 v16, 0x3fb8aa3b, v16
    v_exp_f32 v16, v16
    s_waitcnt vmcnt(6)
    v_perm_b32 v32, v68, v64, s65
    v_perm_b32 v36, v68, v64, s66
    v_perm_b32 v40, v69, v65, s65
    v_perm_b32 v44, v69, v65, s66
    v_perm_b32 v48, v70, v66, s65
    v_perm_b32 v52, v70, v66, s66
    v_perm_b32 v56, v71, v67, s65
    v_perm_b32 v60, v71, v67, s66
    v_perm_b32 v33, v76, v72, s65
    v_perm_b32 v37, v76, v72, s66
    v_perm_b32 v41, v77, v73, s65
    v_perm_b32 v45, v77, v73, s66
    v_perm_b32 v49, v78, v74, s65
    v_perm_b32 v53, v78, v74, s66
    v_perm_b32 v57, v79, v75, s65
    v_perm_b32 v61, v79, v75, s66
    s_waitcnt vmcnt(4)
    v_perm_b32 v34, v84, v80, s65
    v_perm_b32 v38, v84, v80, s66
    v_perm_b32 v42, v85, v81, s65
    v_perm_b32 v46, v85, v81, s66
    v_perm_b32 v50, v86, v82, s65
    v_perm_b32 v54, v86, v82, s66
    v_perm_b32 v58, v87, v83, s65
    v_perm_b32 v62, v87, v83, s66
    s_waitcnt vmcnt(2)
    v_perm_b32 v35, v92, v88, s65
    v_perm_b32 v39, v92, v88, s66
    v_perm_b32 v43, v93, v89, s65
    v_perm_b32 v47, v93, v89, s66
    v_perm_b32 v51, v94, v90, s65
    v_perm_b32 v55, v94, v90, s66
    v_perm_b32 v59, v95, v91, s65
    v_perm_b32 v63, v95, v91, s66
    v_mfma_f32_16x16x32_bf16 v[64:67], v[20:23], v[32:35], 0
    v_mfma_f32_16x16x32_bf16 v[68:71], v[20:23], v[36:39], 0
    v_mfma_f32_16x16x32_bf16 v[72:75], v[20:23], v[40:43], 0
    v_mfma_f32_16x16x32_bf16 v[76:79], v[20:23], v[44:47], 0
    v_mfma_f32_16x16x32_bf16 v[80:83], v[20:23], v[48:51], 0
    v_mfma_f32_16x16x32_bf16 v[84:87], v[20:23], v[52:55], 0
    v_mfma_f32_16x16x32_bf16 v[88:91], v[20:23], v[56:59], 0
    v_mfma_f32_16x16x32_bf16 v[92:95], v[20:23], v[60:63], 0
    s_nop 4
    v_cndmask_b32 v12, v80, v64, s[36:37]
    v_cndmask_b32 v13, v84, v68, s[36:37]
    v_cndmask_b32 v14, v88, v72, s[36:37]
    v_cndmask_b32 v15, v92, v76, s[36:37]
    v_mul_f32 v12, v12, v16
    v_mul_f32 v13, v13, v16
    v_mul_f32 v14, v14, v16
    v_mul_f32 v15, v15, v16
    ds_write_b128 v10, v[12:15] offset:5120
    s_waitcnt lgkmcnt(0)
    s_barrier
    s_barrier
    s_branch Ly
Lax:
    s_lshl_b32 s42, s58, 3
    s_add_u32 s42, s42, s50
    s_mul_i32 s42, s42, 36864
    s_lshl_b32 s43, s59, 7
    s_add_u32 s42, s42, s43
    s_add_u32 s41, s42, 0
    buffer_load_dwordx4 v[96:99], v30, s[20:23], s41 offen nt
    s_waitcnt lgkmcnt(0)
    v_max3_f32 v12, v128, v130, v132
    v_max3_f32 v13, v134, v136, v138
    v_max3_f32 v12, v12, v140, v142
    v_max_f32 v12, v12, v13
    v_sub_f32 v16, v16, v12
    v_mul_f32 v16, 0x3fb8aa3b, v16
    v_exp_f32 v16, v16
    s_waitcnt vmcnt(5)
    v_perm_b32 v32, v68, v64, s65
    v_perm_b32 v36, v68, v64, s66
    v_perm_b32 v40, v69, v65, s65
    v_perm_b32 v44, v69, v65, s66
    v_perm_b32 v48, v70, v66, s65
    v_perm_b32 v52, v70, v66, s66
    v_perm_b32 v56, v71, v67, s65
    v_perm_b32 v60, v71, v67, s66
    v_perm_b32 v33, v76, v72, s65
    v_perm_b32 v37, v76, v72, s66
    v_perm_b32 v41, v77, v73, s65
    v_perm_b32 v45, v77, v73, s66
    v_perm_b32 v49, v78, v74, s65
    v_perm_b32 v53, v78, v74, s66
    v_perm_b32 v57, v79, v75, s65
    v_perm_b32 v61, v79, v75, s66
    s_waitcnt vmcnt(3)
    v_perm_b32 v34, v84, v80, s65
    v_perm_b32 v38, v84, v80, s66
    v_perm_b32 v42, v85, v81, s65
    v_perm_b32 v46, v85, v81, s66
    v_perm_b32 v50, v86, v82, s65
    v_perm_b32 v54, v86, v82, s66
    v_perm_b32 v58, v87, v83, s65
    v_perm_b32 v62, v87, v83, s66
    s_waitcnt vmcnt(1)
    v_perm_b32 v35, v92, v88, s65
    v_perm_b32 v39, v92, v88, s66
    v_perm_b32 v43, v93, v89, s65
    v_perm_b32 v47, v93, v89, s66
    v_perm_b32 v51, v94, v90, s65
    v_perm_b32 v55, v94, v90, s66
    v_perm_b32 v59, v95, v91, s65
    v_perm_b32 v63, v95, v91, s66
    v_mfma_f32_16x16x32_bf16 v[64:67], v[20:23], v[32:35], 0
    v_mfma_f32_16x16x32_bf16 v[68:71], v[20:23], v[36:39], 0
    v_mfma_f32_16x16x32_bf16 v[72:75], v[20:23], v[40:43], 0
    v_mfma_f32_16x16x32_bf16 v[76:79], v[20:23], v[44:47], 0
    v_mfma_f32_16x16x32_bf16 v[80:83], v[20:23], v[48:51], 0
    v_mfma_f32_16x16x32_bf16 v[84:87], v[20:23], v[52:55], 0
    v_mfma_f32_16x16x32_bf16 v[88:91], v[20:23], v[56:59], 0
    v_mfma_f32_16x16x32_bf16 v[92:95], v[20:23], v[60:63], 0
    s_nop 4
    v_cndmask_b32 v12, v80, v64, s[36:37]
    v_cndmask_b32 v13, v84, v68, s[36:37]
    v_cndmask_b32 v14, v88, v72, s[36:37]
    v_cndmask_b32 v15, v92, v76, s[36:37]
    v_mul_f32 v12, v12, v16
    v_mul_f32 v13, v13, v16
    v_mul_f32 v14, v14, v16
    v_mul_f32 v15, v15, v16
    ds_write_b128 v10, v[12:15] offset:5120
    s_waitcnt lgkmcnt(0)
    s_barrier
    s_barrier
    s_add_u32 s41, s42, 4608
    buffer_load_dwordx4 v[100:103], v30, s[20:23], s41 offen nt
    s_add_u32 s41, s42, 9216
    buffer_load_dwordx4 v[104:107], v30, s[20:23], s41 offen nt
    s_add_u32 s41, s42, 13824
    buffer_load_dwordx4 v[108:111], v30, s[20:23], s41 offen nt
    s_mul_i32 s42, s58, 18432
    s_add_u32 s42, s42, 132096
    s_add_u32 s47, s42, 9216
    s_lshl_b32 s43, s50, 7
    s_add_u32 s43, s43, s42
    s_sub_u32 s43, s43, 1024
    s_add_u32 s48, s43, 9216
    v_lshrrev_b32 v8, 3, v1
    v_mul_u32_u24 v8, 1152, v8
    v_and_b32 v9, 7, v1
    v_lshl_add_u32 v9, v9, 4, v8
    s_lshl_b32 s41, s50, 9
    v_add_u32 v24, s41, v26
    s_waitcnt vmcnt(1)
    s_mov_b32 s40, 20000
    buffer_load_dwordx4 v[128:131], v9, s[28:31], s43 offen sc1
    buffer_load_dwordx4 v[136:139], v9, s[28:31], s42 offen sc1
    buffer_load_dwordx4 v[132:135], v9, s[28:31], s48 offen sc1
    buffer_load_dwordx4 v[140:143], v9, s[28:31], s47 offen sc1
    s_waitcnt vmcnt(4)
    v_perm_b32 v32, v100, v96, s65
    v_perm_b32 v33, v108, v104, s65
    v_perm_b32 v34, v100, v96, s66
    v_perm_b32 v35, v108, v104, s66
    v_perm_b32 v36, v101, v97, s65
    v_perm_b32 v37, v109, v105, s65
    v_perm_b32 v38, v101, v97, s66
    v_perm_b32 v39, v109, v105, s66
    v_perm_b32 v40, v102, v98, s65
    v_perm_b32 v41, v110, v106, s65
    v_perm_b32 v42, v102, v98, s66
    v_perm_b32 v43, v110, v106, s66
    v_perm_b32 v44, v103, v99, s65
    v_perm_b32 v45, v111, v107, s65
    v_perm_b32 v46, v103, v99, s66
    v_perm_b32 v47, v111, v107, s66
    s_waitcnt vmcnt(2)
    v_xor_b32 v128, s60, v128
    v_xor_b32 v129, s61, v129
    v_xor_b32 v130, s62, v130
    v_xor_b32 v131, s63, v131
    v_xor_b32 v136, s60, v136
    v_xor_b32 v137, s61, v137
    v_xor_b32 v138, s62, v138
    v_xor_b32 v139, s63, v139
    v_or3_b32 v12, v128, v129, v130
    v_or3_b32 v13, v136, v137, v138
    v_or3_b32 v12, v12, v131, v139
    v_or_b32 v12, v12, v13
    v_cmp_ne_u32_sdwa s[4:5], v12, v28 src0_sel:BYTE_0 src1_sel:DWORD
    s_waitcnt vmcnt(0)
    v_xor_b32 v132, s60, v132
    v_xor_b32 v133, s61, v133
    v_xor_b32 v134, s62, v134
    v_xor_b32 v135, s63, v135
    v_xor_b32 v140, s60, v140
    v_xor_b32 v141, s61, v141
    v_xor_b32 v142, s62, v142
    v_xor_b32 v143, s63, v143
    v_or3_b32 v14, v132, v133, v134
    v_or3_b32 v15, v140, v141, v142
    v_or3_b32 v14, v14, v135, v143
    v_or_b32 v14, v14, v15
    v_cmp_ne_u32_sdwa s[6:7], v14, v28 src0_sel:BYTE_0 src1_sel:DWORD
Lp1:
    s_or_b64 vcc, s[4:5], s[6:7]
    s_cbranch_scc0 Lq1
    s_sub_u32 s40, s40, 1
    s_cbranch_scc1 Lq1
    s_mov_b64 exec, s[4:5]
    s_cbranch_execz Lm1_0
    buffer_load_dwordx4 v[128:131], v9, s[28:31], s43 offen sc1
    buffer_load_dwordx4 v[136:139], v9, s[28:31], s42 offen sc1
Lm1_0:
    s_mov_b64 exec, s[6:7]
    s_cbranch_execz Lm1_1
    buffer_load_dwordx4 v[132:135], v9, s[28:31], s48 offen sc1
    buffer_load_dwordx4 v[140:143], v9, s[28:31], s47 offen sc1
Lm1_1:
    s_waitcnt vmcnt(0)
    s_mov_b64 exec, s[4:5]
    s_cbranch_execz Ln1_0
    v_xor_b32 v128, s60, v128
    v_xor_b32 v129, s61, v129
    v_xor_b32 v130, s62, v130
    v_xor_b32 v131, s63, v131
    v_xor_b32 v136, s60, v136
    v_xor_b32 v137, s61, v137
    v_xor_b32 v138, s62, v138
    v_xor_b32 v139, s63, v139
    v_or3_b32 v12, v128, v129, v130
    v_or3_b32 v13, v136, v137, v138
    v_or3_b32 v12, v12, v131, v139
    v_or_b32 v12, v12, v13
    v_cmp_ne_u32_sdwa s[4:5], v12, v28 src0_sel:BYTE_0 src1_sel:DWORD
Ln1_0:
    s_mov_b64 exec, s[6:7]
    s_cbranch_execz Ln1_1
    v_xor_b32 v132, s60, v132
    v_xor_b32 v133, s61, v133
    v_xor_b32 v134, s62, v134
    v_xor_b32 v135, s63, v135
    v_xor_b32 v140, s60, v140
    v_xor_b32 v141, s61, v141
    v_xor_b32 v142, s62, v142
    v_xor_b32 v143, s63, v143
    v_or3_b32 v14, v132, v133, v134
    v_or3_b32 v15, v140, v141, v142
    v_or3_b32 v14, v14, v135, v143
    v_or_b32 v14, v14, v15
    v_cmp_ne_u32_sdwa s[6:7], v14, v28 src0_sel:BYTE_0 src1_sel:DWORD
Ln1_1:
    s_mov_b64 exec, -1
    s_branch Lp1
Lq1:
    s_cmp_lt_u32 s50, 4
    s_cbranch_scc1 Lx0
    v_mov_b32 v136, v138
    v_mov_b32 v137, v139
    v_mov_b32 v140, v142
    v_mov_b32 v141, v143
Lx0:
    v_max_f32 v12, v136, v140
    s_nop 1
    v_max_f32_dpp v12, v12, v12 row_ror:8 row_mask:0xf bank_mask:0xf
    v_mov_b32 v13, v12
    s_nop 1
    v_permlane16_swap_b32 v13, v12
    v_max_f32 v12, v13, v12
    v_mov_b32 v13, v12
    s_nop 1
    v_permlane32_swap_b32 v13, v12
    v_max_f32 v12, v13, v12
    v_sub_f32 v13, v140, v12
    v_sub_f32 v12, v136, v12
    v_mul_f32 v13, 0x3fb8aa3b, v13
    v_mul_f32 v12, 0x3fb8aa3b, v12
    v_exp_f32 v13, v13
    v_exp_f32 v12, v12
    s_nop 0
    v_mul_f32 v137, v137, v12
    v_fmac_f32 v137, v141, v13
    v_mul_f32 v128, v128, v12
    v_mul_f32 v129, v129, v12
    v_mul_f32 v130, v130, v12
    v_mul_f32 v131, v131, v12
    v_fmac_f32 v128, v132, v13
    v_fmac_f32 v129, v133, v13
    v_fmac_f32 v130, v134, v13
    v_fmac_f32 v131, v135, v13
    v_add_f32_dpp v137, v137, v137 row_ror:8 row_mask:0xf bank_mask:0xf
    v_add_f32_dpp v128, v128, v128 row_ror:8 row_mask:0xf bank_mask:0xf
    v_add_f32_dpp v129, v129, v129 row_ror:8 row_mask:0xf bank_mask:0xf
    v_add_f32_dpp v130, v130, v130 row_ror:8 row_mask:0xf bank_mask:0xf
    v_add_f32_dpp v131, v131, v131 row_ror:8 row_mask:0xf bank_mask:0xf
    v_mov_b32 v13, v137
    v_permlane16_swap_b32 v128, v129
    v_permlane16_swap_b32 v130, v131
    v_permlane16_swap_b32 v13, v137
    v_add_f32 v128, v128, v129
    v_add_f32 v130, v130, v131
    v_add_f32 v13, v13, v137
    v_mov_b32 v12, v13
    v_permlane32_swap_b32 v128, v130
    s_nop 0
    v_permlane32_swap_b32 v12, v13
    v_add_f32 v12, v12, v13
    v_rcp_f32 v12, v12
    v_add_f32 v128, v128, v130
    v_mul_f32 v128, v128, v12
    s_nop 1
    v_mov_b32_dpp v132, v128 quad_perm:[0,0,0,0] row_mask:0xf bank_mask:0xf
    v_mov_b32_dpp v133, v128 quad_perm:[1,1,1,1] row_mask:0xf bank_mask:0xf
    v_mov_b32_dpp v134, v128 quad_perm:[2,2,2,2] row_mask:0xf bank_mask:0xf
    v_mov_b32_dpp v135, v128 quad_perm:[3,3,3,3] row_mask:0xf bank_mask:0xf
    v_cvt_pk_bf16_f32 v12, v132, v133
    v_cvt_pk_bf16_f32 v13, v134, v135
    s_nop 1
    v_mfma_f32_16x16x16_bf16 v[64:67], v[12:13], v[32:33], 0
    v_mfma_f32_16x16x16_bf16 v[68:71], v[12:13], v[34:35], 0
    v_mfma_f32_16x16x16_bf16 v[72:75], v[12:13], v[36:37], 0
    v_mfma_f32_16x16x16_bf16 v[76:79], v[12:13], v[38:39], 0
    v_mfma_f32_16x16x16_bf16 v[80:83], v[12:13], v[40:41], 0
    v_mfma_f32_16x16x16_bf16 v[84:87], v[12:13], v[42:43], 0
    v_mfma_f32_16x16x16_bf16 v[88:91], v[12:13], v[44:45], 0
    v_mfma_f32_16x16x16_bf16 v[92:95], v[12:13], v[46:47], 0
    s_nop 4
    v_cndmask_b32 v20, v80, v64, s[36:37]
    v_cndmask_b32 v21, v84, v68, s[36:37]
    v_cndmask_b32 v22, v88, v72, s[36:37]
    v_cndmask_b32 v23, v92, v76, s[36:37]
    s_mov_b32 exec_lo, 0xff0000ff
    s_mov_b32 exec_hi, 0xff0000ff
    ds_write_b128 v24, v[20:23] offset:5120
    s_mov_b64 exec, -1
    s_waitcnt lgkmcnt(0)
    s_barrier
    s_barrier
    s_branch Lz
Lhelp:
    s_setprio 3
    s_mul_i32 s42, s58, 9
    s_add_u32 s42, s42, s59
    s_mul_i32 s42, s42, 256
    s_add_u32 s42, s42, 2097152
    s_add_u32 s43, s42, 2097152
    s_lshl_b32 s44, s70, 8
    s_add_u32 s44, s44, 589824
    s_cmp_eq_u32 s69, 2
    s_cselect_b32 s42, s44, s42
    v_lshlrev_b32 v24, 7, v1
    v_mov_b32 v25, 0x80000000
    v_cmp_gt_u32 vcc, 2, v1
    s_nop 1
    v_cndmask_b32 v20, v25, v24, vcc
    v_cmp_gt_u32 vcc, 9, v1
    s_nop 1
    v_cndmask_b32 v21, v25, v24, vcc
    buffer_load_dword v32, v20, s[28:31], s55 offen sc1
    buffer_load_dword v33, v21, s[28:31], s51 offen sc1
    buffer_load_dword v34, v20, s[28:31], s42 offen sc1
    buffer_load_dword v35, v20, s[28:31], s43 offen sc1
    s_waitcnt vmcnt(8)
    v_mov_b32 v20, 0x3f803f80
    v_dot2_f32_bf16 v21, v8, v20, 0
    v_dot2_f32_bf16 v22, v8, v8, 0
    v_dot2_f32_bf16 v23, v12, v20, 0
    v_dot2_f32_bf16 v24, v12, v12, 0
    v_dot2_f32_bf16 v21, v9, v20, v21
    v_dot2_f32_bf16 v22, v9, v9, v22
    v_dot2_f32_bf16 v23, v13, v20, v23
    v_dot2_f32_bf16 v24, v13, v13, v24
    v_dot2_f32_bf16 v21, v10, v20, v21
    v_dot2_f32_bf16 v22, v10, v10, v22
    v_dot2_f32_bf16 v23, v14, v20, v23
    v_dot2_f32_bf16 v24, v14, v14, v24
    v_dot2_f32_bf16 v21, v11, v20, v21
    v_dot2_f32_bf16 v22, v11, v11, v22
    v_dot2_f32_bf16 v23, v15, v20, v23
    v_dot2_f32_bf16 v24, v15, v15, v24
    v_readfirstlane_b32 s64, v6
    s_nop 0
    v_add_f32 v23, v21, v23
    v_add_f32 v21, v22, v24
    v_mov_b32 v22, v23
    v_mov_b32 v23, v21
    s_nop 0
    v_add_f32_dpp v22, v22, v22 quad_perm:[1,0,3,2] row_mask:0xf bank_mask:0xf
    v_add_f32_dpp v23, v23, v23 quad_perm:[1,0,3,2] row_mask:0xf bank_mask:0xf
    s_nop 0
    v_add_f32_dpp v22, v22, v22 quad_perm:[2,3,0,1] row_mask:0xf bank_mask:0xf
    v_add_f32_dpp v23, v23, v23 quad_perm:[2,3,0,1] row_mask:0xf bank_mask:0xf
    s_nop 0
    v_add_f32_dpp v22, v22, v22 row_ror:4 row_mask:0xf bank_mask:0xf
    v_add_f32_dpp v23, v23, v23 row_ror:4 row_mask:0xf bank_mask:0xf
    s_nop 0
    v_add_f32_dpp v22, v22, v22 row_ror:8 row_mask:0xf bank_mask:0xf
    v_add_f32_dpp v23, v23, v23 row_ror:8 row_mask:0xf bank_mask:0xf
    v_mov_b32 v20, v22
    v_mov_b32 v21, v23
    s_nop 0
    v_permlane16_swap_b32 v20, v22
    v_permlane16_swap_b32 v21, v23
    v_add_f32 v22, v20, v22
    v_add_f32 v23, v21, v23
    v_mov_b32 v20, v22
    v_mov_b32 v21, v23
    s_nop 0
    v_permlane32_swap_b32 v20, v22
    v_permlane32_swap_b32 v21, v23
    v_add_f32 v22, v20, v22
    v_add_f32 v23, v21, v23
    s_mul_i32 s64, s64, 0x9E3779B1
    s_add_u32 s64, s64, 0x7F4A7C15
    s_and_b32 s60, s64, 0xff
    s_bfe_u32 s61, s64, 0x80008
    s_bfe_u32 s62, s64, 0x80010
    s_lshr_b32 s63, s64, 24
    v_mul_f32 v22, 0x3ae38e39, v22
    v_mul_f32 v23, 0x3ae38e39, v23
    v_fma_f32 v23, -v22, v22, v23
    v_max_f32 v23, 0, v23
    v_cvt_pk_bf16_f32 v21, v22, v23
    v_lshlrev_b32 v22, 16, v21
    v_and_b32 v23, 0xffff0000, v21
    v_add_f32 v23, 0x3727c5ac, v23
    v_cvt_pk_bf16_f32 v23, v23, v23
    v_and_b32 v23, 0xffff0000, v23
    v_sqrt_f32 v23, v23
    s_nop 0
    v_cvt_pk_bf16_f32 v23, v23, v23
    v_and_b32 v23, 0xffff0000, v23
    v_rcp_f32 v23, v23
    v_and_b32 v9, 0xffff0000, v16
    v_lshlrev_b32 v8, 16, v16
    v_and_b32 v11, 0xffff0000, v17
    v_lshlrev_b32 v10, 16, v17
    v_pk_add_f32 v[8:9], v[8:9], v[22:23] op_sel_hi:[1,0] neg_lo:[0,1] neg_hi:[0,1]
    v_pk_add_f32 v[10:11], v[10:11], v[22:23] op_sel_hi:[1,0] neg_lo:[0,1] neg_hi:[0,1]
    v_cvt_pk_bf16_f32 v16, v8, v9
    v_cvt_pk_bf16_f32 v17, v10, v11
    v_and_b32 v9, 0xffff0000, v16
    v_lshlrev_b32 v8, 16, v16
    v_and_b32 v11, 0xffff0000, v17
    v_lshlrev_b32 v10, 16, v17
    v_pk_mul_f32 v[8:9], v[8:9], v[22:23] op_sel:[0,1] op_sel_hi:[1,1]
    v_pk_mul_f32 v[10:11], v[10:11], v[22:23] op_sel:[0,1] op_sel_hi:[1,1]
    v_cvt_pk_bf16_f32 v16, v8, v9
    v_cvt_pk_bf16_f32 v17, v10, v11
    s_lshl_b32 s41, s3, 8
    v_lshl_add_u32 v24, v2, 4, s41
    s_waitcnt vmcnt(4)
    v_perm_b32 v136, v130, v128, s65
    v_perm_b32 v137, v134, v132, s65
    v_perm_b32 v138, v130, v128, s66
    v_perm_b32 v139, v134, v132, s66
    v_perm_b32 v140, v131, v129, s65
    v_perm_b32 v141, v135, v133, s65
    v_perm_b32 v142, v131, v129, s66
    v_perm_b32 v143, v135, v133, s66
    v_mfma_f32_16x16x16_bf16 v[144:147], v[16:17], v[136:137], 0
    v_mfma_f32_16x16x16_bf16 v[148:151], v[16:17], v[138:139], 0
    v_mfma_f32_16x16x16_bf16 v[152:155], v[16:17], v[140:141], 0
    v_mfma_f32_16x16x16_bf16 v[156:159], v[16:17], v[142:143], 0
    s_nop 4
    v_mov_b32 v20, v144
    v_mov_b32 v21, v148
    v_mov_b32 v22, v152
    v_mov_b32 v23, v156
    s_mov_b32 exec_lo, 0xffff
    s_mov_b32 exec_hi, 0
    ds_write_b128 v24, v[20:23]
    s_mov_b64 exec, -1
    s_waitcnt lgkmcnt(0)
    s_barrier
    v_lshlrev_b32 v8, 2, v1
    ds_read2st64_b32 v[128:129], v8 offset0:0 offset1:1
    ds_read2st64_b32 v[130:131], v8 offset0:2 offset1:3
    ds_read2st64_b32 v[132:133], v8 offset0:4 offset1:5
    ds_read2st64_b32 v[134:135], v8 offset0:6 offset1:7
    ds_read_b32 v136, v8 offset:2048
    s_waitcnt lgkmcnt(0)
    v_pk_add_f32 v[128:129], v[128:129], v[130:131]
    v_pk_add_f32 v[132:133], v[132:133], v[134:135]
    v_pk_add_f32 v[128:129], v[128:129], v[132:133]
    v_add_f32 v128, v128, v129
    v_add_f32 v128, v128, v136
    s_nop 1
    v_mov_b32_dpp v129, v128 quad_perm:[1,1,1,1] row_mask:0xf bank_mask:0xf
    v_mov_b32_dpp v130, v128 quad_perm:[2,2,2,2] row_mask:0xf bank_mask:0xf
    v_mov_b32_dpp v131, v128 quad_perm:[3,3,3,3] row_mask:0xf bank_mask:0xf
    v_and_or_b32 v128, v128, v4, s60
    v_and_or_b32 v129, v129, v4, s61
    v_and_or_b32 v130, v130, v4, s62
    v_and_or_b32 v131, v131, v4, s63
    s_mov_b32 exec_lo, 0x11111111
    s_mov_b32 exec_hi, 0x11111111
    buffer_store_dwordx4 v[128:131], v8, s[28:31], s55 offen sc1
    s_mov_b64 exec, -1
    s_lshl_b32 s42, s58, 12
    s_add_u32 s42, s42, 65536
    s_waitcnt vmcnt(0)
    s_mov_b32 s40, 20000
    buffer_load_dwordx4 v[128:131], v7, s[28:31], s42 offen offset:0 sc1
    buffer_load_dwordx4 v[132:135], v7, s[28:31], s42 offen offset:1024 sc1
    buffer_load_dwordx4 v[136:139], v7, s[28:31], s42 offen offset:2048 sc1
    buffer_load_dwordx4 v[140:143], v7, s[28:31], s42 offen offset:3072 sc1
    s_waitcnt vmcnt(0)
Lp2:
    v_xor_b32 v128, s60, v128
    v_xor_b32 v129, s61, v129
    v_xor_b32 v130, s62, v130
    v_xor_b32 v131, s63, v131
    v_xor_b32 v132, s60, v132
    v_xor_b32 v133, s61, v133
    v_xor_b32 v134, s62, v134
    v_xor_b32 v135, s63, v135
    v_xor_b32 v136, s60, v136
    v_xor_b32 v137, s61, v137
    v_xor_b32 v138, s62, v138
    v_xor_b32 v139, s63, v139
    v_xor_b32 v140, s60, v140
    v_xor_b32 v141, s61, v141
    v_xor_b32 v142, s62, v142
    v_xor_b32 v143, s63, v143
    v_or3_b32 v12, v128, v129, v130
    v_or3_b32 v12, v12, v131, v132
    v_or3_b32 v12, v12, v133, v134
    v_or3_b32 v13, v136, v137, v138
    v_or3_b32 v13, v13, v139, v140
    v_or3_b32 v13, v13, v141, v142
    v_or3_b32 v12, v12, v135, v143
    v_or_b32 v12, v12, v13
    v_cmp_ne_u32_sdwa vcc, v12, v28 src0_sel:BYTE_0 src1_sel:DWORD
    s_cbranch_vccz Lq2
    s_sub_u32 s40, s40, 1
    s_cbranch_scc1 Lq2
    s_mov_b64 exec, vcc
    buffer_load_dwordx4 v[128:131], v7, s[28:31], s42 offen offset:0 sc1
    buffer_load_dwordx4 v[132:135], v7, s[28:31], s42 offen offset:1024 sc1
    buffer_load_dwordx4 v[136:139], v7, s[28:31], s42 offen offset:2048 sc1
    buffer_load_dwordx4 v[140:143], v7, s[28:31], s42 offen offset:3072 sc1
    s_waitcnt vmcnt(0)
    s_branch Lp2
Lq2:
    s_mov_b64 exec, -1
    v_add_f32 v128, v128, v132
    v_add_f32 v136, v136, v140
    v_add_f32 v128, v128, v136
    v_add_f32 v129, v129, v133
    v_add_f32 v137, v137, v141
    v_add_f32 v129, v129, v137
    v_add_f32 v130, v130, v134
    v_add_f32 v138, v138, v142
    v_add_f32 v130, v130, v138
    v_add_f32 v131, v131, v135
    v_add_f32 v139, v139, v143
    v_add_f32 v131, v131, v139
    v_cvt_pk_bf16_f32 v12, v128, v129
    v_cvt_pk_bf16_f32 v13, v130, v131
    v_lshlrev_b32 v8, 3, v1
    ds_write_b64 v8, v[12:13] offset:2560
    s_waitcnt lgkmcnt(0)
    s_barrier
    v_lshrrev_b32 v8, 5, v1
    v_lshlrev_b32 v8, 6, v8
    s_barrier
    ds_read_b128 v[128:131], v8 offset:4096
    ds_read_b128 v[132:135], v8 offset:4112
    ds_read_b128 v[136:139], v8 offset:4128
    ds_read_b128 v[140:143], v8 offset:4144
    s_cmp_eq_u32 s69, 2
    s_cbranch_scc0 Lh1
    s_mul_i32 s42, s3, 589824
    s_lshl_b32 s43, s70, 7
    s_add_u32 s42, s42, s43
    s_mul_i32 s43, s70, 73728
    s_lshl_b32 s44, s3, 7
    s_add_u32 s43, s43, s44
    s_add_u32 s41, s42, 0
    buffer_load_dwordx4 v[96:99], v29, s[20:23], s41 offen nt
    s_add_u32 s41, s42, 9216
    buffer_load_dwordx4 v[100:103], v29, s[20:23], s41 offen nt
Lh1:
    s_waitcnt lgkmcnt(0)
    v_max3_f32 v12, v128, v130, v132
    v_max3_f32 v13, v134, v136, v138
    v_max3_f32 v12, v12, v140, v142
    v_max_f32 v12, v12, v13
    v_sub_f32 v128, v128, v12
    v_sub_f32 v130, v130, v12
    v_sub_f32 v132, v132, v12
    v_sub_f32 v134, v134, v12
    v_sub_f32 v136, v136, v12
    v_sub_f32 v138, v138, v12
    v_sub_f32 v140, v140, v12
    v_sub_f32 v142, v142, v12
    v_mul_f32 v128, 0x3fb8aa3b, v128
    v_mul_f32 v130, 0x3fb8aa3b, v130
    v_mul_f32 v132, 0x3fb8aa3b, v132
    v_mul_f32 v134, 0x3fb8aa3b, v134
    v_mul_f32 v136, 0x3fb8aa3b, v136
    v_mul_f32 v138, 0x3fb8aa3b, v138
    v_mul_f32 v140, 0x3fb8aa3b, v140
    v_mul_f32 v142, 0x3fb8aa3b, v142
    v_exp_f32 v128, v128
    v_exp_f32 v130, v130
    v_exp_f32 v132, v132
    v_exp_f32 v134, v134
    v_exp_f32 v136, v136
    v_exp_f32 v138, v138
    v_exp_f32 v140, v140
    v_exp_f32 v142, v142
    v_mul_f32 v128, v128, v129
    v_mul_f32 v130, v130, v131
    v_mul_f32 v132, v132, v133
    v_mul_f32 v134, v134, v135
    v_mul_f32 v136, v136, v137
    v_mul_f32 v138, v138, v139
    v_mul_f32 v140, v140, v141
    v_mul_f32 v142, v142, v143
    v_add_f32 v128, v128, v130
    v_add_f32 v132, v132, v134
    v_add_f32 v136, v136, v138
    v_add_f32 v140, v140, v142
    v_add_f32 v128, v128, v132
    v_add_f32 v136, v136, v140
    v_add_f32 v128, v128, v136
    v_mov_b32 v14, v12
    v_mov_b32 v13, v128
    v_mov_b32 v15, v128
    v_permlane32_swap_b32 v12, v14
    s_nop 0
    v_permlane32_swap_b32 v13, v15
    v_and_or_b32 v12, v12, v4, s60
    v_and_or_b32 v13, v13, v4, s61
    v_and_or_b32 v14, v14, v4, s62
    v_and_or_b32 v15, v15, v4, s63
    s_barrier
    ds_read_b128 v[128:131], v7 offset:5120
    ds_read_b128 v[132:135], v7 offset:6144
    ds_read_b128 v[136:139], v7 offset:7168
    ds_read_b128 v[140:143], v7 offset:8192
    ds_read_b128 v[144:147], v7 offset:9216
    ds_read_b128 v[148:151], v7 offset:10240
    ds_read_b128 v[152:155], v7 offset:11264
    ds_read_b128 v[156:159], v7 offset:12288
    s_mov_b32 exec_lo, 0xff
    s_mov_b32 exec_hi, 0
    buffer_store_dwordx4 v[12:15], v7, s[28:31], s51 offen offset:1024 sc1
    s_mov_b64 exec, -1
    s_waitcnt lgkmcnt(0)
    v_pk_add_f32 v[128:129], v[128:129], v[144:145]
    v_pk_add_f32 v[130:131], v[130:131], v[146:147]
    v_pk_add_f32 v[132:133], v[132:133], v[148:149]
    v_pk_add_f32 v[134:135], v[134:135], v[150:151]
    v_pk_add_f32 v[136:137], v[136:137], v[152:153]
    v_pk_add_f32 v[138:139], v[138:139], v[154:155]
    v_pk_add_f32 v[140:141], v[140:141], v[156:157]
    v_pk_add_f32 v[142:143], v[142:143], v[158:159]
    v_pk_add_f32 v[128:129], v[128:129], v[136:137]
    v_pk_add_f32 v[130:131], v[130:131], v[138:139]
    v_pk_add_f32 v[132:133], v[132:133], v[140:141]
    v_pk_add_f32 v[134:135], v[134:135], v[142:143]
    v_pk_add_f32 v[128:129], v[128:129], v[132:133]
    v_pk_add_f32 v[130:131], v[130:131], v[134:135]
    v_and_or_b32 v128, v128, v4, s60
    v_and_or_b32 v129, v129, v4, s61
    v_and_or_b32 v130, v130, v4, s62
    v_and_or_b32 v131, v131, v4, s63
    buffer_store_dwordx4 v[128:131], v7, s[28:31], s51 offen sc1
    s_cmp_eq_u32 s69, 2
    s_cbranch_scc0 Lh2
    s_barrier
Lh2:
    s_cmp_eq_u32 s69, 2
    s_cbranch_scc1 Ly
    s_cmp_eq_u32 s69, 1
    s_cbranch_scc0 Lfin
    s_mul_i32 s42, s58, 9
    s_add_u32 s42, s42, s59
    s_mul_i32 s42, s42, 256
    s_add_u32 s49, s42, 2097152
    s_barrier
    s_barrier
    v_lshlrev_b32 v8, 2, v1
    ds_read2st64_b32 v[128:129], v8 offset0:20 offset1:21
    ds_read2st64_b32 v[130:131], v8 offset0:22 offset1:23
    ds_read2st64_b32 v[132:133], v8 offset0:24 offset1:25
    ds_read2st64_b32 v[134:135], v8 offset0:26 offset1:27
    ds_read2st64_b32 v[136:137], v8 offset0:28 offset1:29
    ds_read2st64_b32 v[138:139], v8 offset0:30 offset1:31
    ds_read2st64_b32 v[140:141], v8 offset0:32 offset1:33
    ds_read2st64_b32 v[142:143], v8 offset0:34 offset1:35
    s_waitcnt lgkmcnt(0)
    v_pk_add_f32 v[128:129], v[128:129], v[130:131]
    v_pk_add_f32 v[132:133], v[132:133], v[134:135]
    v_pk_add_f32 v[136:137], v[136:137], v[138:139]
    v_pk_add_f32 v[140:141], v[140:141], v[142:143]
    v_pk_add_f32 v[128:129], v[128:129], v[132:133]
    v_pk_add_f32 v[136:137], v[136:137], v[140:141]
    v_pk_add_f32 v[128:129], v[128:129], v[136:137]
    v_add_f32 v128, v128, v129
    s_nop 1
    v_mov_b32_dpp v129, v128 quad_perm:[1,1,1,1] row_mask:0xf bank_mask:0xf
    v_mov_b32_dpp v130, v128 quad_perm:[2,2,2,2] row_mask:0xf bank_mask:0xf
    v_mov_b32_dpp v131, v128 quad_perm:[3,3,3,3] row_mask:0xf bank_mask:0xf
    v_and_or_b32 v128, v128, v4, s60
    v_and_or_b32 v129, v129, v4, s61
    v_and_or_b32 v130, v130, v4, s62
    v_and_or_b32 v131, v131, v4, s63
    s_mov_b32 exec_lo, 0x11111111
    s_mov_b32 exec_hi, 0x11111111
    buffer_store_dwordx4 v[128:131], v8, s[28:31], s49 offen sc1
    s_mov_b64 exec, -1
    s_waitcnt vmcnt(0)
    s_barrier
Lz:
    s_mul_i32 s42, s58, 9
    s_add_u32 s42, s42, s3
    s_lshl_b32 s43, s42, 7
    s_add_u32 s43, s43, 589824
    s_mul_i32 s42, s42, 36864
    s_lshl_b32 s44, s59, 7
    s_add_u32 s42, s42, s44
    s_add_u32 s41, s42, 0
    buffer_load_dwordx4 v[96:99], v27, s[24:27], s41 offen nt
    s_add_u32 s41, s42, 1152
    buffer_load_dwordx4 v[100:103], v27, s[24:27], s41 offen nt
    s_add_u32 s41, s42, 2304
    buffer_load_dwordx4 v[104:107], v27, s[24:27], s41 offen nt
    s_add_u32 s41, s42, 3456
    buffer_load_dwordx4 v[108:111], v27, s[24:27], s41 offen nt
    v_bfe_u32 v10, v2, 2, 1
    v_lshl_add_u32 v10, v10, 2, v3
    v_lshlrev_b32 v10, 4, v10
    s_lshl_b32 s41, s3, 9
    v_add_u32 v24, s41, v26
    s_waitcnt vmcnt(0)
    v_perm_b32 v32, v100, v96, s65
    v_perm_b32 v33, v108, v104, s65
    v_perm_b32 v34, v100, v96, s66
    v_perm_b32 v35, v108, v104, s66
    v_perm_b32 v36, v101, v97, s65
    v_perm_b32 v37, v109, v105, s65
    v_perm_b32 v38, v101, v97, s66
    v_perm_b32 v39, v109, v105, s66
    v_perm_b32 v40, v102, v98, s65
    v_perm_b32 v41, v110, v106, s65
    v_perm_b32 v42, v102, v98, s66
    v_perm_b32 v43, v110, v106, s66
    v_perm_b32 v44, v103, v99, s65
    v_perm_b32 v45, v111, v107, s65
    v_perm_b32 v46, v103, v99, s66
    v_perm_b32 v47, v111, v107, s66
    s_mov_b32 s40, 20000
    buffer_load_dwordx4 v[96:99], v10, s[28:31], s43 offen sc1
    buffer_load_dwordx4 v[100:103], v10, s[28:31], s43 offen sc1
    buffer_load_dwordx4 v[104:107], v10, s[28:31], s43 offen sc1
Lp3:
    s_waitcnt vmcnt(2)
    v_xor_b32 v96, s60, v96
    v_xor_b32 v97, s61, v97
    v_xor_b32 v98, s62, v98
    v_xor_b32 v99, s63, v99
    v_or3_b32 v12, v96, v97, v98
    v_or_b32 v12, v12, v99
    v_cmp_ne_u32_sdwa vcc, v12, v28 src0_sel:BYTE_0 src1_sel:DWORD
    s_cbranch_vccz Lq3_0
    buffer_load_dwordx4 v[96:99], v10, s[28:31], s43 offen sc1
    s_waitcnt vmcnt(2)
    v_xor_b32 v100, s60, v100
    v_xor_b32 v101, s61, v101
    v_xor_b32 v102, s62, v102
    v_xor_b32 v103, s63, v103
    v_or3_b32 v12, v100, v101, v102
    v_or_b32 v12, v12, v103
    v_cmp_ne_u32_sdwa vcc, v12, v28 src0_sel:BYTE_0 src1_sel:DWORD
    s_cbranch_vccz Lq3_1
    buffer_load_dwordx4 v[100:103], v10, s[28:31], s43 offen sc1
    s_waitcnt vmcnt(2)
    v_xor_b32 v104, s60, v104
    v_xor_b32 v105, s61, v105
    v_xor_b32 v106, s62, v106
    v_xor_b32 v107, s63, v107
    v_or3_b32 v12, v104, v105, v106
    v_or_b32 v12, v12, v107
    v_cmp_ne_u32_sdwa vcc, v12, v28 src0_sel:BYTE_0 src1_sel:DWORD
    s_cbranch_vccz Lq3_2
    buffer_load_dwordx4 v[104:107], v10, s[28:31], s43 offen sc1
    s_sub_u32 s40, s40, 1
    s_cbranch_scc0 Lp3
Lq3_0:
    v_perm_b32 v12, v97, v96, s66
    v_perm_b32 v13, v99, v98, s66
    s_branch Lq3
Lq3_1:
    v_perm_b32 v12, v101, v100, s66
    v_perm_b32 v13, v103, v102, s66
    s_branch Lq3
Lq3_2:
    v_perm_b32 v12, v105, v104, s66
    v_perm_b32 v13, v107, v106, s66
Lq3:
    s_nop 1
    v_mfma_f32_16x16x16_bf16 v[64:67], v[12:13], v[32:33], 0
    v_mfma_f32_16x16x16_bf16 v[68:71], v[12:13], v[34:35], 0
    v_mfma_f32_16x16x16_bf16 v[72:75], v[12:13], v[36:37], 0
    v_mfma_f32_16x16x16_bf16 v[76:79], v[12:13], v[38:39], 0
    v_mfma_f32_16x16x16_bf16 v[80:83], v[12:13], v[40:41], 0
    v_mfma_f32_16x16x16_bf16 v[84:87], v[12:13], v[42:43], 0
    v_mfma_f32_16x16x16_bf16 v[88:91], v[12:13], v[44:45], 0
    v_mfma_f32_16x16x16_bf16 v[92:95], v[12:13], v[46:47], 0
    s_nop 4
    v_cndmask_b32 v20, v80, v64, s[36:37]
    v_cndmask_b32 v21, v84, v68, s[36:37]
    v_cndmask_b32 v22, v88, v72, s[36:37]
    v_cndmask_b32 v23, v92, v76, s[36:37]
    s_mov_b32 exec_lo, 0xff0000ff
    s_mov_b32 exec_hi, 0xff0000ff
    ds_write_b128 v24, v[20:23] offset:5120
    s_mov_b64 exec, -1
    s_waitcnt lgkmcnt(0)
    s_barrier
    s_cmp_eq_u32 s3, 0
    s_cbranch_scc0 Lfin
    s_add_u32 s49, s49, 2097152
    v_lshlrev_b32 v8, 2, v1
    ds_read2st64_b32 v[128:129], v8 offset0:20 offset1:21
    ds_read2st64_b32 v[130:131], v8 offset0:22 offset1:23
    ds_read2st64_b32 v[132:133], v8 offset0:24 offset1:25
    ds_read2st64_b32 v[134:135], v8 offset0:26 offset1:27
    ds_read2st64_b32 v[136:137], v8 offset0:28 offset1:29
    ds_read2st64_b32 v[138:139], v8 offset0:30 offset1:31
    ds_read2st64_b32 v[140:141], v8 offset0:32 offset1:33
    ds_read2st64_b32 v[142:143], v8 offset0:34 offset1:35
    ds_read2st64_b32 v[144:145], v8 offset0:36 offset1:37
    s_waitcnt lgkmcnt(0)
    v_pk_add_f32 v[128:129], v[128:129], v[130:131]
    v_pk_add_f32 v[132:133], v[132:133], v[134:135]
    v_pk_add_f32 v[136:137], v[136:137], v[138:139]
    v_pk_add_f32 v[140:141], v[140:141], v[142:143]
    v_pk_add_f32 v[128:129], v[128:129], v[132:133]
    v_pk_add_f32 v[136:137], v[136:137], v[140:141]
    v_pk_add_f32 v[128:129], v[128:129], v[136:137]
    v_pk_add_f32 v[128:129], v[128:129], v[144:145]
    v_add_f32 v128, v128, v129
    s_nop 1
    v_mov_b32_dpp v129, v128 quad_perm:[1,1,1,1] row_mask:0xf bank_mask:0xf
    v_mov_b32_dpp v130, v128 quad_perm:[2,2,2,2] row_mask:0xf bank_mask:0xf
    v_mov_b32_dpp v131, v128 quad_perm:[3,3,3,3] row_mask:0xf bank_mask:0xf
    v_and_or_b32 v128, v128, v4, s60
    v_and_or_b32 v129, v129, v4, s61
    v_and_or_b32 v130, v130, v4, s62
    v_and_or_b32 v131, v131, v4, s63
    s_mov_b32 exec_lo, 0x11111111
    s_mov_b32 exec_hi, 0x11111111
    buffer_store_dwordx4 v[128:131], v8, s[28:31], s49 offen sc1
    s_mov_b64 exec, -1
    s_branch Lfin
Ly:
    s_add_u32 s41, s42, 18432
    buffer_load_dwordx4 v[104:107], v29, s[20:23], s41 offen nt
    s_add_u32 s41, s42, 27648
    buffer_load_dwordx4 v[108:111], v29, s[20:23], s41 offen nt
    s_add_u32 s41, s42, 36864
    buffer_load_dwordx4 v[112:115], v29, s[20:23], s41 offen nt
    s_add_u32 s41, s42, 46080
    buffer_load_dwordx4 v[116:119], v29, s[20:23], s41 offen nt
    s_add_u32 s41, s42, 55296
    buffer_load_dwordx4 v[120:123], v29, s[20:23], s41 offen nt
    s_add_u32 s41, s42, 64512
    buffer_load_dwordx4 v[124:127], v29, s[20:23], s41 offen nt
    v_lshrrev_b32 v8, 2, v2
    v_mul_u32_u24 v8, 9216, v8
    v_and_b32 v9, 3, v2
    v_lshl_add_u32 v9, v3, 2, v9
    v_lshl_add_u32 v8, v9, 4, v8
    s_mul_i32 s41, s3, 256
    v_add_u32 v8, s41, v8
    s_lshl_b32 s41, s3, 7
    v_lshl_add_u32 v9, v9, 3, s41
    v_bfe_u32 v10, v2, 2, 1
    v_lshl_add_u32 v10, v10, 2, v3
    v_lshl_add_u32 v10, v10, 4, s41
    s_lshl_b32 s41, s3, 9
    v_add_u32 v24, s41, v26
    s_lshl_b32 s41, s3, 3
    v_mov_b32 v25, s41
    v_mov_b32 v16, 0x3f803f80
    v_mov_b32 v17, 0x3f803f80
    s_mov_b32 s42, 2098176
    s_lshl_b32 s43, s70, 8
    s_add_u32 s43, s43, 589824
    v_and_b32 v65, 0xffff0000, v18
    v_lshlrev_b32 v64, 16, v18
    v_and_b32 v67, 0xffff0000, v19
    v_lshlrev_b32 v66, 16, v19
    s_waitcnt vmcnt(2)
    s_cmp_eq_u32 s3, 0
    s_cbranch_scc0 Lg1
    v_mul_u32_u24 v14, 2304, v1
    s_mov_b32 s40, 20000
    s_mov_b64 exec, 0xffff
Lg0:
    buffer_load_dwordx4 v[128:131], v14, s[28:31], s42 offen sc1
    s_waitcnt vmcnt(0)
    v_xor_b32 v128, s60, v128
    v_xor_b32 v129, s61, v129
    v_xor_b32 v130, s62, v130
    v_xor_b32 v131, s63, v131
    v_or3_b32 v12, v128, v129, v130
    v_or_b32 v12, v12, v131
    v_cmp_ne_u32_sdwa vcc, v12, v28 src0_sel:BYTE_0 src1_sel:DWORD
    s_bcnt1_i32_b64 s41, vcc
    s_cmp_le_u32 s41, 10
    s_cbranch_scc1 Lg2
    s_mov_b64 exec, vcc
    s_sub_u32 s40, s40, 1
    s_cbranch_scc0 Lg0
Lg2:
    s_mov_b64 exec, -1
Lg1:
    s_barrier
    s_mov_b32 s52, 2097152
    s_mov_b32 s53, 2099456
    s_mov_b32 s54, 2101760
    s_mov_b32 s55, 2104064
    s_mov_b32 s40, 20000
    buffer_load_dwordx4 v[128:131], v8, s[28:31], s52 offen sc1
    buffer_load_dwordx4 v[132:135], v8, s[28:31], s53 offen sc1
    buffer_load_dwordx4 v[136:139], v8, s[28:31], s54 offen sc1
    buffer_load_dwordx4 v[140:143], v8, s[28:31], s55 offen sc1
    s_waitcnt vmcnt(4)
    v_perm_b32 v32, v100, v96, s65
    v_perm_b32 v33, v108, v104, s65
    v_perm_b32 v34, v116, v112, s65
    v_perm_b32 v35, v124, v120, s65
    v_perm_b32 v36, v100, v96, s66
    v_perm_b32 v37, v108, v104, s66
    v_perm_b32 v38, v116, v112, s66
    v_perm_b32 v39, v124, v120, s66
    v_perm_b32 v40, v101, v97, s65
    v_perm_b32 v41, v109, v105, s65
    v_perm_b32 v42, v117, v113, s65
    v_perm_b32 v43, v125, v121, s65
    v_perm_b32 v44, v101, v97, s66
    v_perm_b32 v45, v109, v105, s66
    v_perm_b32 v46, v117, v113, s66
    v_perm_b32 v47, v125, v121, s66
    v_perm_b32 v48, v102, v98, s65
    v_perm_b32 v49, v110, v106, s65
    v_perm_b32 v50, v118, v114, s65
    v_perm_b32 v51, v126, v122, s65
    v_perm_b32 v52, v102, v98, s66
    v_perm_b32 v53, v110, v106, s66
    v_perm_b32 v54, v118, v114, s66
    v_perm_b32 v55, v126, v122, s66
    v_perm_b32 v56, v103, v99, s65
    v_perm_b32 v57, v111, v107, s65
    v_perm_b32 v58, v119, v115, s65
    v_perm_b32 v59, v127, v123, s65
    v_perm_b32 v60, v103, v99, s66
    v_perm_b32 v61, v111, v107, s66
    v_perm_b32 v62, v119, v115, s66
    v_perm_b32 v63, v127, v123, s66
    s_waitcnt vmcnt(3)
    v_xor_b32 v128, s60, v128
    v_xor_b32 v129, s61, v129
    v_xor_b32 v130, s62, v130
    v_xor_b32 v131, s63, v131
    v_or3_b32 v12, v128, v129, v130
    v_or_b32 v12, v12, v131
    v_cmp_ne_u32_sdwa s[4:5], v12, v28 src0_sel:BYTE_0 src1_sel:DWORD
    s_waitcnt vmcnt(2)
    v_xor_b32 v132, s60, v132
    v_xor_b32 v133, s61, v133
    v_xor_b32 v134, s62, v134
    v_xor_b32 v135, s63, v135
    v_or3_b32 v14, v132, v133, v134
    v_or_b32 v14, v14, v135
    v_cmp_ne_u32_sdwa s[6:7], v14, v28 src0_sel:BYTE_0 src1_sel:DWORD
    s_waitcnt vmcnt(1)
    v_xor_b32 v136, s60, v136
    v_xor_b32 v137, s61, v137
    v_xor_b32 v138, s62, v138
    v_xor_b32 v139, s63, v139
    v_or3_b32 v12, v136, v137, v138
    v_or_b32 v12, v12, v139
    v_cmp_ne_u32_sdwa s[8:9], v12, v28 src0_sel:BYTE_0 src1_sel:DWORD
    s_waitcnt vmcnt(0)
    v_xor_b32 v140, s60, v140
    v_xor_b32 v141, s61, v141
    v_xor_b32 v142, s62, v142
    v_xor_b32 v143, s63, v143
    v_or3_b32 v14, v140, v141, v142
    v_or_b32 v14, v14, v143
    v_cmp_ne_u32_sdwa s[10:11], v14, v28 src0_sel:BYTE_0 src1_sel:DWORD
Lp4:
    s_or_b64 vcc, s[4:5], s[6:7]
    s_or_b64 vcc, vcc, s[8:9]
    s_or_b64 vcc, vcc, s[10:11]
    s_cbranch_scc0 Lq4
    s_sub_u32 s40, s40, 1
    s_cbranch_scc1 Lq4
    s_mov_b64 exec, s[4:5]
    s_cbranch_execz Lm4_0
    buffer_load_dwordx4 v[128:131], v8, s[28:31], s52 offen sc1
Lm4_0:
    s_mov_b64 exec, s[6:7]
    s_cbranch_execz Lm4_1
    buffer_load_dwordx4 v[132:135], v8, s[28:31], s53 offen sc1
Lm4_1:
    s_mov_b64 exec, s[8:9]
    s_cbranch_execz Lm4_2
    buffer_load_dwordx4 v[136:139], v8, s[28:31], s54 offen sc1
Lm4_2:
    s_mov_b64 exec, s[10:11]
    s_cbranch_execz Lm4_3
    buffer_load_dwordx4 v[140:143], v8, s[28:31], s55 offen sc1
Lm4_3:
    s_waitcnt vmcnt(0)
    s_mov_b64 exec, s[4:5]
    s_cbranch_execz Ln4_0
    v_xor_b32 v128, s60, v128
    v_xor_b32 v129, s61, v129
    v_xor_b32 v130, s62, v130
    v_xor_b32 v131, s63, v131
    v_or3_b32 v12, v128, v129, v130
    v_or_b32 v12, v12, v131
    v_cmp_ne_u32_sdwa s[4:5], v12, v28 src0_sel:BYTE_0 src1_sel:DWORD
Ln4_0:
    s_mov_b64 exec, s[6:7]
    s_cbranch_execz Ln4_1
    v_xor_b32 v132, s60, v132
    v_xor_b32 v133, s61, v133
    v_xor_b32 v134, s62, v134
    v_xor_b32 v135, s63, v135
    v_or3_b32 v14, v132, v133, v134
    v_or_b32 v14, v14, v135
    v_cmp_ne_u32_sdwa s[6:7], v14, v28 src0_sel:BYTE_0 src1_sel:DWORD
Ln4_1:
    s_mov_b64 exec, s[8:9]
    s_cbranch_execz Ln4_2
    v_xor_b32 v136, s60, v136
    v_xor_b32 v137, s61, v137
    v_xor_b32 v138, s62, v138
    v_xor_b32 v139, s63, v139
    v_or3_b32 v12, v136, v137, v138
    v_or_b32 v12, v12, v139
    v_cmp_ne_u32_sdwa s[8:9], v12, v28 src0_sel:BYTE_0 src1_sel:DWORD
Ln4_2:
    s_mov_b64 exec, s[10:11]
    s_cbranch_execz Ln4_3
    v_xor_b32 v140, s60, v140
    v_xor_b32 v141, s61, v141
    v_xor_b32 v142, s62, v142
    v_xor_b32 v143, s63, v143
    v_or3_b32 v14, v140, v141, v142
    v_or_b32 v14, v14, v143
    v_cmp_ne_u32_sdwa s[10:11], v14, v28 src0_sel:BYTE_0 src1_sel:DWORD
Ln4_3:
    s_mov_b64 exec, -1
    s_branch Lp4
Lq4:
    v_pk_add_f32 v[128:129], v[128:129], v[136:137]
    v_pk_add_f32 v[130:131], v[130:131], v[138:139]
    v_pk_add_f32 v[132:133], v[132:133], v[140:141]
    v_pk_add_f32 v[134:135], v[134:135], v[142:143]
    v_pk_add_f32 v[128:129], v[128:129], v[132:133]
    v_pk_add_f32 v[130:131], v[130:131], v[134:135]
    s_nop 0
    v_add_f32_dpp v128, v128, v128 row_ror:4 row_mask:0xf bank_mask:0xf
    v_add_f32_dpp v129, v129, v129 row_ror:4 row_mask:0xf bank_mask:0xf
    v_add_f32_dpp v130, v130, v130 row_ror:4 row_mask:0xf bank_mask:0xf
    v_add_f32_dpp v131, v131, v131 row_ror:4 row_mask:0xf bank_mask:0xf
    v_add_f32_dpp v128, v128, v128 row_ror:8 row_mask:0xf bank_mask:0xf
    v_add_f32_dpp v129, v129, v129 row_ror:8 row_mask:0xf bank_mask:0xf
    v_add_f32_dpp v130, v130, v130 row_ror:8 row_mask:0xf bank_mask:0xf
    v_add_f32_dpp v131, v131, v131 row_ror:8 row_mask:0xf bank_mask:0xf
    v_cvt_pk_bf16_f32 v12, v128, v129
    v_cvt_pk_bf16_f32 v13, v130, v131
    v_and_b32 v129, 0xffff0000, v12
    v_lshlrev_b32 v128, 16, v12
    v_and_b32 v131, 0xffff0000, v13
    v_lshlrev_b32 v130, 16, v13
    v_pk_add_f32 v[128:129], v[128:129], v[64:65]
    v_pk_add_f32 v[130:131], v[130:131], v[66:67]
    v_cvt_pk_bf16_f32 v12, v128, v129
    v_cvt_pk_bf16_f32 v13, v130, v131
    s_nop 1
    v_mfma_f32_16x16x16_bf16 v[136:139], v[12:13], v[12:13], 0
    v_mfma_f32_16x16x16_bf16 v[132:135], v[12:13], v[16:17], 0
    v_and_b32 v65, 0xffff0000, v12
    v_lshlrev_b32 v64, 16, v12
    v_and_b32 v67, 0xffff0000, v13
    v_lshlrev_b32 v66, 16, v13
    s_nop 2
    v_add_f32_dpp v136, v137, v136 quad_perm:[1,1,1,1] row_mask:0xf bank_mask:0xf
    s_nop 1
    v_add_f32_dpp v136, v138, v136 quad_perm:[2,2,2,2] row_mask:0xf bank_mask:0xf
    s_nop 1
    v_add_f32_dpp v136, v139, v136 quad_perm:[3,3,3,3] row_mask:0xf bank_mask:0xf
    v_pk_add_f32 v[132:133], v[132:133], v[134:135]
    v_add_f32 v22, v132, v133
    v_mov_b32 v23, v136
    s_mov_b32 exec_lo, 1
    s_mov_b32 exec_hi, 0
    ds_write_b64 v25, v[22:23] offset:15616
    s_mov_b64 exec, -1
    s_waitcnt lgkmcnt(0)
    s_barrier
    ds_read_b128 v[136:139], v28 offset:15616
    ds_read_b128 v[140:143], v28 offset:15632
    ds_read_b128 v[144:147], v28 offset:15648
    ds_read_b128 v[148:151], v28 offset:15664
    ds_read_b64 v[22:23], v28 offset:15680
    s_waitcnt lgkmcnt(0)
    v_pk_add_f32 v[136:137], v[136:137], v[144:145]
    v_pk_add_f32 v[138:139], v[138:139], v[146:147]
    v_pk_add_f32 v[140:141], v[140:141], v[148:149]
    v_pk_add_f32 v[142:143], v[142:143], v[150:151]
    v_pk_add_f32 v[136:137], v[136:137], v[140:141]
    v_pk_add_f32 v[138:139], v[138:139], v[142:143]
    v_pk_add_f32 v[136:137], v[136:137], v[138:139]
    v_pk_add_f32 v[22:23], v[22:23], v[136:137]
    v_mul_f32 v22, 0x3ae38e39, v22
    v_mul_f32 v23, 0x3ae38e39, v23
    v_fma_f32 v23, -v22, v22, v23
    v_max_f32 v23, 0, v23
    v_cvt_pk_bf16_f32 v21, v22, v23
    v_lshlrev_b32 v22, 16, v21
    v_and_b32 v23, 0xffff0000, v21
    v_add_f32 v23, 0x3727c5ac, v23
    v_cvt_pk_bf16_f32 v23, v23, v23
    v_and_b32 v23, 0xffff0000, v23
    v_sqrt_f32 v23, v23
    s_nop 0
    v_cvt_pk_bf16_f32 v23, v23, v23
    v_and_b32 v23, 0xffff0000, v23
    v_rcp_f32 v23, v23
    s_nop 0
    v_pk_add_f32 v[128:129], v[64:65], v[22:23] op_sel_hi:[1,0] neg_lo:[0,1] neg_hi:[0,1]
    v_pk_add_f32 v[130:131], v[66:67], v[22:23] op_sel_hi:[1,0] neg_lo:[0,1] neg_hi:[0,1]
    v_cvt_pk_bf16_f32 v12, v128, v129
    v_cvt_pk_bf16_f32 v13, v130, v131
    v_and_b32 v129, 0xffff0000, v12
    v_lshlrev_b32 v128, 16, v12
    v_and_b32 v131, 0xffff0000, v13
    v_lshlrev_b32 v130, 16, v13
    v_pk_mul_f32 v[128:129], v[128:129], v[22:23] op_sel:[0,1] op_sel_hi:[1,1]
    v_pk_mul_f32 v[130:131], v[130:131], v[22:23] op_sel:[0,1] op_sel_hi:[1,1]
    v_cvt_pk_bf16_f32 v12, v128, v129
    v_cvt_pk_bf16_f32 v13, v130, v131
    ds_write_b64 v9, v[12:13] offset:15872
    ds_read_b128 v[12:15], v10 offset:15872
    s_waitcnt lgkmcnt(0)
    v_mfma_f32_16x16x32_bf16 v[128:131], v[12:15], v[32:35], 0
    v_mfma_f32_16x16x32_bf16 v[132:135], v[12:15], v[36:39], 0
    v_mfma_f32_16x16x32_bf16 v[136:139], v[12:15], v[40:43], 0
    v_mfma_f32_16x16x32_bf16 v[140:143], v[12:15], v[44:47], 0
    v_mfma_f32_16x16x32_bf16 v[144:147], v[12:15], v[48:51], 0
    v_mfma_f32_16x16x32_bf16 v[148:151], v[12:15], v[52:55], 0
    v_mfma_f32_16x16x32_bf16 v[152:155], v[12:15], v[56:59], 0
    v_mfma_f32_16x16x32_bf16 v[156:159], v[12:15], v[60:63], 0
    s_nop 4
    v_cndmask_b32 v20, v144, v128, s[36:37]
    v_cndmask_b32 v21, v148, v132, s[36:37]
    v_cndmask_b32 v22, v152, v136, s[36:37]
    v_cndmask_b32 v23, v156, v140, s[36:37]
    s_mov_b32 exec_lo, 0xff0000ff
    s_mov_b32 exec_hi, 0xff0000ff
    ds_write_b128 v24, v[20:23] offset:5120
    s_mov_b64 exec, -1
    s_waitcnt lgkmcnt(0)
    s_barrier
    s_cmp_eq_u32 s3, 0
    s_cbranch_scc0 Ly2
    v_mov_b32 v14, v8
    v_lshlrev_b32 v8, 2, v1
    ds_read2st64_b32 v[128:129], v8 offset0:20 offset1:21
    ds_read2st64_b32 v[130:131], v8 offset0:22 offset1:23
    ds_read2st64_b32 v[132:133], v8 offset0:24 offset1:25
    ds_read2st64_b32 v[134:135], v8 offset0:26 offset1:27
    ds_read2st64_b32 v[136:137], v8 offset0:28 offset1:29
    ds_read2st64_b32 v[138:139], v8 offset0:30 offset1:31
    ds_read2st64_b32 v[140:141], v8 offset0:32 offset1:33
    ds_read2st64_b32 v[142:143], v8 offset0:34 offset1:35
    ds_read2st64_b32 v[144:145], v8 offset0:36 offset1:37
    s_waitcnt lgkmcnt(0)
    v_pk_add_f32 v[128:129], v[128:129], v[130:131]
    v_pk_add_f32 v[132:133], v[132:133], v[134:135]
    v_pk_add_f32 v[136:137], v[136:137], v[138:139]
    v_pk_add_f32 v[140:141], v[140:141], v[142:143]
    v_pk_add_f32 v[128:129], v[128:129], v[132:133]
    v_pk_add_f32 v[136:137], v[136:137], v[140:141]
    v_pk_add_f32 v[128:129], v[128:129], v[136:137]
    v_pk_add_f32 v[128:129], v[128:129], v[144:145]
    v_add_f32 v128, v128, v129
    v_max_f32 v128, 0, v128
    v_cvt_pk_bf16_f32 v128, v128, v128
    s_nop 1
    v_mov_b32_dpp v129, v128 quad_perm:[1,1,1,1] row_mask:0xf bank_mask:0xf
    v_mov_b32_dpp v130, v128 quad_perm:[2,2,2,2] row_mask:0xf bank_mask:0xf
    v_mov_b32_dpp v131, v128 quad_perm:[3,3,3,3] row_mask:0xf bank_mask:0xf
    v_and_or_b32 v128, v128, v4, s60
    v_and_or_b32 v129, v129, v4, s61
    v_and_or_b32 v130, v130, v4, s62
    v_and_or_b32 v131, v131, v4, s63
    s_mov_b32 exec_lo, 0x11111111
    s_mov_b32 exec_hi, 0x11111111
    buffer_store_dwordx4 v[128:131], v8, s[28:31], s43 offen sc1
    s_mov_b64 exec, -1
    v_mov_b32 v8, v14
Ly2:
    s_lshl_b32 s41, s3, 3
    s_cmp_eq_u32 s41, s70
    s_cbranch_scc0 Lfin
    s_mov_b32 s42, 4194304
    s_mov_b32 s52, 4194304
    s_mov_b32 s53, 4196608
    s_mov_b32 s54, 4198912
    s_mov_b32 s55, 4201216
    s_mov_b32 s40, 20000
    buffer_load_dwordx4 v[32:35], v8, s[28:31], s52 offen sc1
    buffer_load_dwordx4 v[36:39], v8, s[28:31], s53 offen sc1
    buffer_load_dwordx4 v[40:43], v8, s[28:31], s54 offen sc1
    buffer_load_dwordx4 v[44:47], v8, s[28:31], s55 offen sc1
    buffer_load_dwordx4 v[48:51], v8, s[28:31], s52 offen sc1
    buffer_load_dwordx4 v[52:55], v8, s[28:31], s53 offen sc1
    buffer_load_dwordx4 v[56:59], v8, s[28:31], s54 offen sc1
    buffer_load_dwordx4 v[60:63], v8, s[28:31], s55 offen sc1
    buffer_load_dwordx4 v[96:99], v8, s[28:31], s52 offen sc1
    buffer_load_dwordx4 v[100:103], v8, s[28:31], s53 offen sc1
    buffer_load_dwordx4 v[104:107], v8, s[28:31], s54 offen sc1
    buffer_load_dwordx4 v[108:111], v8, s[28:31], s55 offen sc1
Lp5:
    s_waitcnt vmcnt(8)
    v_xor_b32 v32, s60, v32
    v_xor_b32 v33, s61, v33
    v_xor_b32 v34, s62, v34
    v_xor_b32 v35, s63, v35
    v_xor_b32 v36, s60, v36
    v_xor_b32 v37, s61, v37
    v_xor_b32 v38, s62, v38
    v_xor_b32 v39, s63, v39
    v_xor_b32 v40, s60, v40
    v_xor_b32 v41, s61, v41
    v_xor_b32 v42, s62, v42
    v_xor_b32 v43, s63, v43
    v_xor_b32 v44, s60, v44
    v_xor_b32 v45, s61, v45
    v_xor_b32 v46, s62, v46
    v_xor_b32 v47, s63, v47
    v_or3_b32 v12, v32, v33, v34
    v_or3_b32 v12, v12, v35, v36
    v_or3_b32 v12, v12, v37, v38
    v_or3_b32 v13, v40, v41, v42
    v_or3_b32 v13, v13, v43, v44
    v_or3_b32 v13, v13, v45, v46
    v_or3_b32 v12, v12, v39, v47
    v_or_b32 v12, v12, v13
    v_cmp_ne_u32_sdwa vcc, v12, v28 src0_sel:BYTE_0 src1_sel:DWORD
    s_cbranch_vccz Lq5_0
    buffer_load_dwordx4 v[32:35], v8, s[28:31], s52 offen sc1
    buffer_load_dwordx4 v[36:39], v8, s[28:31], s53 offen sc1
    buffer_load_dwordx4 v[40:43], v8, s[28:31], s54 offen sc1
    buffer_load_dwordx4 v[44:47], v8, s[28:31], s55 offen sc1
    s_waitcnt vmcnt(8)
    v_xor_b32 v48, s60, v48
    v_xor_b32 v49, s61, v49
    v_xor_b32 v50, s62, v50
    v_xor_b32 v51, s63, v51
    v_xor_b32 v52, s60, v52
    v_xor_b32 v53, s61, v53
    v_xor_b32 v54, s62, v54
    v_xor_b32 v55, s63, v55
    v_xor_b32 v56, s60, v56
    v_xor_b32 v57, s61, v57
    v_xor_b32 v58, s62, v58
    v_xor_b32 v59, s63, v59
    v_xor_b32 v60, s60, v60
    v_xor_b32 v61, s61, v61
    v_xor_b32 v62, s62, v62
    v_xor_b32 v63, s63, v63
    v_or3_b32 v12, v48, v49, v50
    v_or3_b32 v12, v12, v51, v52
    v_or3_b32 v12, v12, v53, v54
    v_or3_b32 v13, v56, v57, v58
    v_or3_b32 v13, v13, v59, v60
    v_or3_b32 v13, v13, v61, v62
    v_or3_b32 v12, v12, v55, v63
    v_or_b32 v12, v12, v13
    v_cmp_ne_u32_sdwa vcc, v12, v28 src0_sel:BYTE_0 src1_sel:DWORD
    s_cbranch_vccz Lq5_1
    buffer_load_dwordx4 v[48:51], v8, s[28:31], s52 offen sc1
    buffer_load_dwordx4 v[52:55], v8, s[28:31], s53 offen sc1
    buffer_load_dwordx4 v[56:59], v8, s[28:31], s54 offen sc1
    buffer_load_dwordx4 v[60:63], v8, s[28:31], s55 offen sc1
    s_waitcnt vmcnt(8)
    v_xor_b32 v96, s60, v96
    v_xor_b32 v97, s61, v97
    v_xor_b32 v98, s62, v98
    v_xor_b32 v99, s63, v99
    v_xor_b32 v100, s60, v100
    v_xor_b32 v101, s61, v101
    v_xor_b32 v102, s62, v102
    v_xor_b32 v103, s63, v103
    v_xor_b32 v104, s60, v104
    v_xor_b32 v105, s61, v105
    v_xor_b32 v106, s62, v106
    v_xor_b32 v107, s63, v107
    v_xor_b32 v108, s60, v108
    v_xor_b32 v109, s61, v109
    v_xor_b32 v110, s62, v110
    v_xor_b32 v111, s63, v111
    v_or3_b32 v12, v96, v97, v98
    v_or3_b32 v12, v12, v99, v100
    v_or3_b32 v12, v12, v101, v102
    v_or3_b32 v13, v104, v105, v106
    v_or3_b32 v13, v13, v107, v108
    v_or3_b32 v13, v13, v109, v110
    v_or3_b32 v12, v12, v103, v111
    v_or_b32 v12, v12, v13
    v_cmp_ne_u32_sdwa vcc, v12, v28 src0_sel:BYTE_0 src1_sel:DWORD
    s_cbranch_vccz Lq5_2
    buffer_load_dwordx4 v[96:99], v8, s[28:31], s52 offen sc1
    buffer_load_dwordx4 v[100:103], v8, s[28:31], s53 offen sc1
    buffer_load_dwordx4 v[104:107], v8, s[28:31], s54 offen sc1
    buffer_load_dwordx4 v[108:111], v8, s[28:31], s55 offen sc1
    s_sub_u32 s40, s40, 1
    s_cbranch_scc0 Lp5
Lq5_0:
    v_pk_add_f32 v[128:129], v[32:33], v[40:41]
    v_pk_add_f32 v[130:131], v[34:35], v[42:43]
    v_pk_add_f32 v[132:133], v[36:37], v[44:45]
    v_pk_add_f32 v[134:135], v[38:39], v[46:47]
    s_branch Lq5
Lq5_1:
    v_pk_add_f32 v[128:129], v[48:49], v[56:57]
    v_pk_add_f32 v[130:131], v[50:51], v[58:59]
    v_pk_add_f32 v[132:133], v[52:53], v[60:61]
    v_pk_add_f32 v[134:135], v[54:55], v[62:63]
    s_branch Lq5
Lq5_2:
    v_pk_add_f32 v[128:129], v[96:97], v[104:105]
    v_pk_add_f32 v[130:131], v[98:99], v[106:107]
    v_pk_add_f32 v[132:133], v[100:101], v[108:109]
    v_pk_add_f32 v[134:135], v[102:103], v[110:111]
Lq5:
    v_pk_add_f32 v[128:129], v[128:129], v[132:133]
    v_pk_add_f32 v[130:131], v[130:131], v[134:135]
    s_nop 0
    v_add_f32_dpp v128, v128, v128 row_ror:4 row_mask:0xf bank_mask:0xf
    v_add_f32_dpp v129, v129, v129 row_ror:4 row_mask:0xf bank_mask:0xf
    v_add_f32_dpp v130, v130, v130 row_ror:4 row_mask:0xf bank_mask:0xf
    v_add_f32_dpp v131, v131, v131 row_ror:4 row_mask:0xf bank_mask:0xf
    v_add_f32_dpp v128, v128, v128 row_ror:8 row_mask:0xf bank_mask:0xf
    v_add_f32_dpp v129, v129, v129 row_ror:8 row_mask:0xf bank_mask:0xf
    v_add_f32_dpp v130, v130, v130 row_ror:8 row_mask:0xf bank_mask:0xf
    v_add_f32_dpp v131, v131, v131 row_ror:8 row_mask:0xf bank_mask:0xf
    v_cvt_pk_bf16_f32 v12, v128, v129
    v_cvt_pk_bf16_f32 v13, v130, v131
    v_and_b32 v129, 0xffff0000, v12
    v_lshlrev_b32 v128, 16, v12
    v_and_b32 v131, 0xffff0000, v13
    v_lshlrev_b32 v130, 16, v13
    v_pk_add_f32 v[128:129], v[128:129], v[64:65]
    v_pk_add_f32 v[130:131], v[130:131], v[66:67]
    v_cvt_pk_bf16_f32 v12, v128, v129
    v_cvt_pk_bf16_f32 v13, v130, v131
    s_mov_b32 exec_lo, 0x000f000f
    s_mov_b32 exec_hi, 0x000f000f
    buffer_store_dwordx2 v[12:13], v9, s[32:35], 0 offen
    s_cmp_eq_u32 s3, 0
    s_cbranch_scc0 Lfin
    v_mov_b32 v12, s64
    s_mov_b32 exec_lo, 1
    s_mov_b32 exec_hi, 0
    buffer_store_dword v12, v28, s[28:31], 0 offen sc1
Lfin:
    s_waitcnt vmcnt(0)
Lend:
s_endpgm
.section .rodata,"a"
.p2align 6
.amdhsa_kernel sequential_preLN__sliding_block_cached__dense_activation_relu__decode_kernel
  .amdhsa_next_free_vgpr 160
  .amdhsa_next_free_sgpr 102
  .amdhsa_accum_offset 160
  .amdhsa_group_segment_fixed_size 0
  .amdhsa_kernarg_size 88
  .amdhsa_user_sgpr_count 2
  .amdhsa_user_sgpr_kernarg_segment_ptr 1
  .amdhsa_system_sgpr_workgroup_id_x 1
.end_amdhsa_kernel
```
